```python
import torch

def _softmax(x, axis=-1):
    return torch.softmax(x, dim=axis)
def _gelu(x):
    return torch.nn.functional.gelu(x, approximate="tanh")
def _silu(x):
    return torch.nn.functional.silu(x)
def _sigmoid(x):
    return torch.sigmoid(x)
def _layernorm(x, axis=-1, eps=1e-5):
    m = x.mean(dim=axis, keepdim=True)
    v = x.var(dim=axis, keepdim=True, unbiased=False)
    return (x - m) / torch.sqrt(v + eps)
def _scatter_add(tgt, idx, src, axis=0):
    return tgt.clone().index_add_(axis, idx, src)
def _segment_sum(src, seg, n):
    out = torch.zeros((n,) + src.shape[1:], dtype=src.dtype)
    return out.index_add_(0, seg, src)
def _pad(x, pw):
    flat = tuple(v for pair in reversed(pw) for v in pair)
    return torch.nn.functional.pad(x, flat)

kernel_name = 'standalone__groupnorm__prompt'

def setup_inputs():

    _w = (lambda a: (lambda t: t.to(torch.bfloat16) if t.is_floating_point() else t)(torch.as_tensor(a)))
    B = 1
    G = 32
    cpg = max(1, 448 // G)
    C = G * cpg
    H, W = 16, 2048
    return {
        "x": _w(abs((lambda *s: torch.randn(*s, dtype=torch.bfloat16) * 0.05)(B, C, H, W))),
        "g": _w((lambda *s: torch.randn(*s, dtype=torch.bfloat16) * 0.05)(C) + 1.0),
        "b": _w((lambda *s: torch.randn(*s, dtype=torch.bfloat16) * 0.4)(C)),
    }

def reference(x, g, b):
    G = 32
    B, C, H, W = x.shape[0], x.shape[1], x.shape[2], x.shape[3]
    xr = x.reshape(B, G, C // G, H, W)
    mu = xr.mean(axis=(2, 3, 4), keepdims=True)
    var = ((xr - mu) ** 2).mean(axis=(2, 3, 4), keepdims=True)
    xn = (xr - mu) / torch.sqrt(var + 1e-5)
    xn = xn.reshape(B, C, H, W)
    return xn * g[None, :, None, None] + b[None, :, None, None]
```

```asm
; @launch grid=(256,1,1) block=(320,1,1) lds=4352
.amdgcn_target "amdgcn-amd-amdhsa--gfx950"
.text
.globl standalone__groupnorm__prompt_kernel
.p2align 12
.p2align 8
.type standalone__groupnorm__prompt_kernel,@function
standalone__groupnorm__prompt_kernel:
  s_cmpk_ge_u32 s2, 256
  s_cbranch_scc1 L_end
  s_load_dwordx2 s[16:17], s[0:1], 0
  s_load_dwordx2 s[20:21], s[0:1], 24
  v_readfirstlane_b32 s3, v0
  s_and_b32 s25, s2, 15
  s_lshr_b32 s26, s2, 4
  s_mul_i32 s27, s25, 917504
  s_mov_b32 s18, 29360128
  s_mov_b32 s19, 0x20000
  s_mov_b32 s31, 0x3f803f80
  s_cmpk_eq_u32 s3, 256
  s_cbranch_scc1 L_sync
  s_lshl_b32 s24, s26, 12
  v_lshl_add_u32 v2, v0, 4, s24
  v_xor_b32 v3, 0x2000, v2
  s_mov_b32 s28, s27
  s_mov_b32 s33, 0x10000
  s_getpc_b64 s[14:15]
L_pc:
  v_lshlrev_b32 v9, 6, v0
  v_cmp_gt_u32 vcc, L_tier2-L_pc, v9
  s_and_saveexec_b64 s[24:25], vcc
  s_cbranch_execz L_nopf
  global_load_dword v14, v9, s[14:15]
L_nopf:
  s_mov_b64 exec, s[24:25]
  s_waitcnt lgkmcnt(0)
  buffer_load_dwordx4 v[16:19], v2, s[16:19], s28 offen nt
  s_add_u32 s28, s28, s33
  buffer_load_dwordx4 v[20:23], v3, s[16:19], s28 offen nt
  s_add_u32 s28, s28, s33
  buffer_load_dwordx4 v[24:27], v2, s[16:19], s28 offen nt
  s_add_u32 s28, s28, s33
  buffer_load_dwordx4 v[28:31], v3, s[16:19], s28 offen nt
  s_add_u32 s28, s28, s33
  buffer_load_dwordx4 v[32:35], v2, s[16:19], s28 offen nt
  s_add_u32 s28, s28, s33
  buffer_load_dwordx4 v[36:39], v3, s[16:19], s28 offen nt
  s_add_u32 s28, s28, s33
  buffer_load_dwordx4 v[40:43], v2, s[16:19], s28 offen nt
  s_add_u32 s28, s28, s33
  buffer_load_dwordx4 v[44:47], v3, s[16:19], s28 offen nt
  s_add_u32 s28, s28, s33
  s_mov_b32 s22, s18
  s_mov_b32 s23, 0x20000
  v_mov_b32 v10, 0
  v_mov_b32 v11, 0
  v_mov_b32 v12, 0
  v_mov_b32 v13, 0
  v_lshlrev_b32 v4, 3, v0
  v_mov_b32 v5, 0
  s_mov_b32 s30, 0xffff0000
  s_mov_b32 s29, s27
  s_waitcnt vmcnt(7)
  buffer_load_dwordx4 v[48:51], v2, s[16:19], s28 offen nt
  s_add_u32 s28, s28, s33
  v_dot2_f32_bf16 v10, v16, s31, v10
  v_dot2_f32_bf16 v11, v16, v16, v11
  v_dot2_f32_bf16 v12, v17, s31, v12
  v_dot2_f32_bf16 v13, v17, v17, v13
  v_dot2_f32_bf16 v10, v18, s31, v10
  v_dot2_f32_bf16 v11, v18, v18, v11
  v_dot2_f32_bf16 v12, v19, s31, v12
  v_dot2_f32_bf16 v13, v19, v19, v13
  s_waitcnt vmcnt(7)
  buffer_load_dwordx4 v[52:55], v3, s[16:19], s28 offen nt
  s_add_u32 s28, s28, s33
  v_dot2_f32_bf16 v10, v20, s31, v10
  v_dot2_f32_bf16 v11, v20, v20, v11
  v_dot2_f32_bf16 v12, v21, s31, v12
  v_dot2_f32_bf16 v13, v21, v21, v13
  v_dot2_f32_bf16 v10, v22, s31, v10
  v_dot2_f32_bf16 v11, v22, v22, v11
  v_dot2_f32_bf16 v12, v23, s31, v12
  v_dot2_f32_bf16 v13, v23, v23, v13
  s_waitcnt vmcnt(7)
  buffer_load_dwordx4 v[56:59], v2, s[16:19], s28 offen nt
  s_add_u32 s28, s28, s33
  v_dot2_f32_bf16 v10, v24, s31, v10
  v_dot2_f32_bf16 v11, v24, v24, v11
  v_dot2_f32_bf16 v12, v25, s31, v12
  v_dot2_f32_bf16 v13, v25, v25, v13
  v_dot2_f32_bf16 v10, v26, s31, v10
  v_dot2_f32_bf16 v11, v26, v26, v11
  v_dot2_f32_bf16 v12, v27, s31, v12
  v_dot2_f32_bf16 v13, v27, v27, v13
  s_waitcnt vmcnt(7)
  buffer_load_dwordx4 v[60:63], v3, s[16:19], s28 offen nt
  s_add_u32 s28, s28, s33
  v_dot2_f32_bf16 v10, v28, s31, v10
  v_dot2_f32_bf16 v11, v28, v28, v11
  v_dot2_f32_bf16 v12, v29, s31, v12
  v_dot2_f32_bf16 v13, v29, v29, v13
  v_dot2_f32_bf16 v10, v30, s31, v10
  v_dot2_f32_bf16 v11, v30, v30, v11
  v_dot2_f32_bf16 v12, v31, s31, v12
  v_dot2_f32_bf16 v13, v31, v31, v13
  s_waitcnt vmcnt(7)
  buffer_load_dwordx4 v[64:67], v2, s[16:19], s28 offen nt
  s_add_u32 s28, s28, s33
  v_dot2_f32_bf16 v10, v32, s31, v10
  v_dot2_f32_bf16 v11, v32, v32, v11
  v_dot2_f32_bf16 v12, v33, s31, v12
  v_dot2_f32_bf16 v13, v33, v33, v13
  v_dot2_f32_bf16 v10, v34, s31, v10
  v_dot2_f32_bf16 v11, v34, v34, v11
  v_dot2_f32_bf16 v12, v35, s31, v12
  v_dot2_f32_bf16 v13, v35, v35, v13
  s_waitcnt vmcnt(7)
  buffer_load_dwordx4 v[68:71], v3, s[16:19], s28 offen nt
  s_add_u32 s28, s28, 13828096
  v_dot2_f32_bf16 v10, v36, s31, v10
  v_dot2_f32_bf16 v11, v36, v36, v11
  v_dot2_f32_bf16 v12, v37, s31, v12
  v_dot2_f32_bf16 v13, v37, v37, v13
  v_dot2_f32_bf16 v10, v38, s31, v10
  v_dot2_f32_bf16 v11, v38, v38, v11
  v_dot2_f32_bf16 v12, v39, s31, v12
  v_dot2_f32_bf16 v13, v39, v39, v13
  s_waitcnt vmcnt(7)
  buffer_load_dwordx4 v[72:75], v2, s[16:19], s28 offen nt
  s_add_u32 s28, s28, s33
  v_dot2_f32_bf16 v10, v40, s31, v10
  v_dot2_f32_bf16 v11, v40, v40, v11
  v_dot2_f32_bf16 v12, v41, s31, v12
  v_dot2_f32_bf16 v13, v41, v41, v13
  v_dot2_f32_bf16 v10, v42, s31, v10
  v_dot2_f32_bf16 v11, v42, v42, v11
  v_dot2_f32_bf16 v12, v43, s31, v12
  v_dot2_f32_bf16 v13, v43, v43, v13
  s_waitcnt vmcnt(7)
  buffer_load_dwordx4 v[76:79], v3, s[16:19], s28 offen nt
  s_add_u32 s28, s28, s33
  v_dot2_f32_bf16 v10, v44, s31, v10
  v_dot2_f32_bf16 v11, v44, v44, v11
  v_dot2_f32_bf16 v12, v45, s31, v12
  v_dot2_f32_bf16 v13, v45, v45, v13
  v_dot2_f32_bf16 v10, v46, s31, v10
  v_dot2_f32_bf16 v11, v46, v46, v11
  v_dot2_f32_bf16 v12, v47, s31, v12
  v_dot2_f32_bf16 v13, v47, v47, v13
  s_waitcnt vmcnt(7)
  buffer_load_dwordx4 v[80:83], v2, s[16:19], s28 offen nt
  s_add_u32 s28, s28, s33
  v_dot2_f32_bf16 v10, v48, s31, v10
  v_dot2_f32_bf16 v11, v48, v48, v11
  v_dot2_f32_bf16 v12, v49, s31, v12
  v_dot2_f32_bf16 v13, v49, v49, v13
  v_dot2_f32_bf16 v10, v50, s31, v10
  v_dot2_f32_bf16 v11, v50, v50, v11
  v_dot2_f32_bf16 v12, v51, s31, v12
  v_dot2_f32_bf16 v13, v51, v51, v13
  s_waitcnt vmcnt(7)
  buffer_load_dwordx4 v[84:87], v3, s[16:19], s28 offen nt
  s_add_u32 s28, s28, s33
  v_dot2_f32_bf16 v10, v52, s31, v10
  v_dot2_f32_bf16 v11, v52, v52, v11
  v_dot2_f32_bf16 v12, v53, s31, v12
  v_dot2_f32_bf16 v13, v53, v53, v13
  v_dot2_f32_bf16 v10, v54, s31, v10
  v_dot2_f32_bf16 v11, v54, v54, v11
  v_dot2_f32_bf16 v12, v55, s31, v12
  v_dot2_f32_bf16 v13, v55, v55, v13
  s_waitcnt vmcnt(7)
  buffer_load_dwordx4 v[88:91], v2, s[16:19], s28 offen nt
  s_add_u32 s28, s28, s33
  v_dot2_f32_bf16 v10, v56, s31, v10
  v_dot2_f32_bf16 v11, v56, v56, v11
  v_dot2_f32_bf16 v12, v57, s31, v12
  v_dot2_f32_bf16 v13, v57, v57, v13
  v_dot2_f32_bf16 v10, v58, s31, v10
  v_dot2_f32_bf16 v11, v58, v58, v11
  v_dot2_f32_bf16 v12, v59, s31, v12
  v_dot2_f32_bf16 v13, v59, v59, v13
  s_waitcnt vmcnt(7)
  buffer_load_dwordx4 v[92:95], v3, s[16:19], s28 offen nt
  s_add_u32 s28, s28, s33
  v_dot2_f32_bf16 v10, v60, s31, v10
  v_dot2_f32_bf16 v11, v60, v60, v11
  v_dot2_f32_bf16 v12, v61, s31, v12
  v_dot2_f32_bf16 v13, v61, v61, v13
  v_dot2_f32_bf16 v10, v62, s31, v10
  v_dot2_f32_bf16 v11, v62, v62, v11
  v_dot2_f32_bf16 v12, v63, s31, v12
  v_dot2_f32_bf16 v13, v63, v63, v13
  s_waitcnt vmcnt(7)
  buffer_load_dwordx4 v[96:99], v2, s[16:19], s28 offen nt
  s_add_u32 s28, s28, s33
  v_dot2_f32_bf16 v10, v64, s31, v10
  v_dot2_f32_bf16 v11, v64, v64, v11
  v_dot2_f32_bf16 v12, v65, s31, v12
  v_dot2_f32_bf16 v13, v65, v65, v13
  v_dot2_f32_bf16 v10, v66, s31, v10
  v_dot2_f32_bf16 v11, v66, v66, v11
  v_dot2_f32_bf16 v12, v67, s31, v12
  v_dot2_f32_bf16 v13, v67, v67, v13
  s_waitcnt vmcnt(7)
  buffer_load_dwordx4 v[100:103], v3, s[16:19], s28 offen nt
  s_add_u32 s28, s28, s33
  v_dot2_f32_bf16 v10, v68, s31, v10
  v_dot2_f32_bf16 v11, v68, v68, v11
  v_dot2_f32_bf16 v12, v69, s31, v12
  v_dot2_f32_bf16 v13, v69, v69, v13
  v_dot2_f32_bf16 v10, v70, s31, v10
  v_dot2_f32_bf16 v11, v70, v70, v11
  v_dot2_f32_bf16 v12, v71, s31, v12
  v_dot2_f32_bf16 v13, v71, v71, v13
  s_nop 2
  v_pk_add_f32 v[8:9], v[10:11], v[12:13]
  v_mov_b32 v10, 0
  v_mov_b32 v11, 0
  v_mov_b32 v12, 0
  v_mov_b32 v13, 0
  ds_write_b64 v4, v[8:9] offset:0
  s_waitcnt lgkmcnt(0)
  s_barrier
  s_waitcnt vmcnt(7)
  buffer_load_dwordx4 v[104:107], v2, s[16:19], s28 offen nt
  s_add_u32 s28, s28, s33
  v_dot2_f32_bf16 v10, v72, s31, v10
  v_dot2_f32_bf16 v11, v72, v72, v11
  v_dot2_f32_bf16 v12, v73, s31, v12
  v_dot2_f32_bf16 v13, v73, v73, v13
  v_dot2_f32_bf16 v10, v74, s31, v10
  v_dot2_f32_bf16 v11, v74, v74, v11
  v_dot2_f32_bf16 v12, v75, s31, v12
  v_dot2_f32_bf16 v13, v75, v75, v13
  s_waitcnt vmcnt(7)
  buffer_load_dwordx4 v[108:111], v3, s[16:19], s28 offen nt
  s_add_u32 s28, s28, s33
  v_dot2_f32_bf16 v10, v76, s31, v10
  v_dot2_f32_bf16 v11, v76, v76, v11
  v_dot2_f32_bf16 v12, v77, s31, v12
  v_dot2_f32_bf16 v13, v77, v77, v13
  v_dot2_f32_bf16 v10, v78, s31, v10
  v_dot2_f32_bf16 v11, v78, v78, v11
  v_dot2_f32_bf16 v12, v79, s31, v12
  v_dot2_f32_bf16 v13, v79, v79, v13
  s_waitcnt vmcnt(7)
  buffer_load_dwordx4 v[112:115], v2, s[16:19], s28 offen nt
  s_add_u32 s28, s28, s33
  v_dot2_f32_bf16 v10, v80, s31, v10
  v_dot2_f32_bf16 v11, v80, v80, v11
  v_dot2_f32_bf16 v12, v81, s31, v12
  v_dot2_f32_bf16 v13, v81, v81, v13
  v_dot2_f32_bf16 v10, v82, s31, v10
  v_dot2_f32_bf16 v11, v82, v82, v11
  v_dot2_f32_bf16 v12, v83, s31, v12
  v_dot2_f32_bf16 v13, v83, v83, v13
  s_waitcnt vmcnt(7)
  buffer_load_dwordx4 v[116:119], v3, s[16:19], s28 offen nt
  s_add_u32 s28, s28, s33
  s_barrier
  v_dot2_f32_bf16 v10, v84, s31, v10
  v_dot2_f32_bf16 v11, v84, v84, v11
  v_dot2_f32_bf16 v12, v85, s31, v12
  v_dot2_f32_bf16 v13, v85, v85, v13
  v_dot2_f32_bf16 v10, v86, s31, v10
  v_dot2_f32_bf16 v11, v86, v86, v11
  v_dot2_f32_bf16 v12, v87, s31, v12
  v_dot2_f32_bf16 v13, v87, v87, v13
  s_waitcnt vmcnt(7)
  buffer_load_dwordx4 v[120:123], v2, s[16:19], s28 offen nt
  s_add_u32 s28, s28, s33
  v_dot2_f32_bf16 v10, v88, s31, v10
  v_dot2_f32_bf16 v11, v88, v88, v11
  v_dot2_f32_bf16 v12, v89, s31, v12
  v_dot2_f32_bf16 v13, v89, v89, v13
  v_dot2_f32_bf16 v10, v90, s31, v10
  v_dot2_f32_bf16 v11, v90, v90, v11
  v_dot2_f32_bf16 v12, v91, s31, v12
  v_dot2_f32_bf16 v13, v91, v91, v13
  s_waitcnt vmcnt(7)
  buffer_load_dwordx4 v[124:127], v3, s[16:19], s28 offen nt
  v_dot2_f32_bf16 v10, v92, s31, v10
  v_dot2_f32_bf16 v11, v92, v92, v11
  v_dot2_f32_bf16 v12, v93, s31, v12
  v_dot2_f32_bf16 v13, v93, v93, v13
  v_dot2_f32_bf16 v10, v94, s31, v10
  v_dot2_f32_bf16 v11, v94, v94, v11
  v_dot2_f32_bf16 v12, v95, s31, v12
  v_dot2_f32_bf16 v13, v95, v95, v13
  s_waitcnt vmcnt(7)
  v_dot2_f32_bf16 v10, v96, s31, v10
  v_dot2_f32_bf16 v11, v96, v96, v11
  v_dot2_f32_bf16 v12, v97, s31, v12
  v_dot2_f32_bf16 v13, v97, v97, v13
  v_dot2_f32_bf16 v10, v98, s31, v10
  v_dot2_f32_bf16 v11, v98, v98, v11
  v_dot2_f32_bf16 v12, v99, s31, v12
  v_dot2_f32_bf16 v13, v99, v99, v13
  s_waitcnt vmcnt(6)
  v_dot2_f32_bf16 v10, v100, s31, v10
  v_dot2_f32_bf16 v11, v100, v100, v11
  v_dot2_f32_bf16 v12, v101, s31, v12
  v_dot2_f32_bf16 v13, v101, v101, v13
  v_dot2_f32_bf16 v10, v102, s31, v10
  v_dot2_f32_bf16 v11, v102, v102, v11
  v_dot2_f32_bf16 v12, v103, s31, v12
  v_dot2_f32_bf16 v13, v103, v103, v13
  s_waitcnt vmcnt(5)
  v_dot2_f32_bf16 v10, v104, s31, v10
  v_dot2_f32_bf16 v11, v104, v104, v11
  v_dot2_f32_bf16 v12, v105, s31, v12
  v_dot2_f32_bf16 v13, v105, v105, v13
  v_dot2_f32_bf16 v10, v106, s31, v10
  v_dot2_f32_bf16 v11, v106, v106, v11
  v_dot2_f32_bf16 v12, v107, s31, v12
  v_dot2_f32_bf16 v13, v107, v107, v13
  s_waitcnt vmcnt(4)
  v_dot2_f32_bf16 v10, v108, s31, v10
  v_dot2_f32_bf16 v11, v108, v108, v11
  v_dot2_f32_bf16 v12, v109, s31, v12
  v_dot2_f32_bf16 v13, v109, v109, v13
  v_dot2_f32_bf16 v10, v110, s31, v10
  v_dot2_f32_bf16 v11, v110, v110, v11
  v_dot2_f32_bf16 v12, v111, s31, v12
  v_dot2_f32_bf16 v13, v111, v111, v13
  s_waitcnt vmcnt(3)
  v_dot2_f32_bf16 v10, v112, s31, v10
  v_dot2_f32_bf16 v11, v112, v112, v11
  v_dot2_f32_bf16 v12, v113, s31, v12
  v_dot2_f32_bf16 v13, v113, v113, v13
  v_dot2_f32_bf16 v10, v114, s31, v10
  v_dot2_f32_bf16 v11, v114, v114, v11
  v_dot2_f32_bf16 v12, v115, s31, v12
  v_dot2_f32_bf16 v13, v115, v115, v13
  s_waitcnt vmcnt(2)
  v_dot2_f32_bf16 v10, v116, s31, v10
  v_dot2_f32_bf16 v11, v116, v116, v11
  v_dot2_f32_bf16 v12, v117, s31, v12
  v_dot2_f32_bf16 v13, v117, v117, v13
  v_dot2_f32_bf16 v10, v118, s31, v10
  v_dot2_f32_bf16 v11, v118, v118, v11
  v_dot2_f32_bf16 v12, v119, s31, v12
  v_dot2_f32_bf16 v13, v119, v119, v13
  s_waitcnt vmcnt(1)
  v_dot2_f32_bf16 v10, v120, s31, v10
  v_dot2_f32_bf16 v11, v120, v120, v11
  v_dot2_f32_bf16 v12, v121, s31, v12
  v_dot2_f32_bf16 v13, v121, v121, v13
  v_dot2_f32_bf16 v10, v122, s31, v10
  v_dot2_f32_bf16 v11, v122, v122, v11
  v_dot2_f32_bf16 v12, v123, s31, v12
  v_dot2_f32_bf16 v13, v123, v123, v13
  s_waitcnt vmcnt(0)
  v_dot2_f32_bf16 v10, v124, s31, v10
  v_dot2_f32_bf16 v11, v124, v124, v11
  v_dot2_f32_bf16 v12, v125, s31, v12
  v_dot2_f32_bf16 v13, v125, v125, v13
  v_dot2_f32_bf16 v10, v126, s31, v10
  v_dot2_f32_bf16 v11, v126, v126, v11
  v_dot2_f32_bf16 v12, v127, s31, v12
  v_dot2_f32_bf16 v13, v127, v127, v13
  s_nop 2
  v_pk_add_f32 v[8:9], v[10:11], v[12:13]
  ds_write_b64 v4, v[8:9] offset:2048
  s_waitcnt lgkmcnt(0)
  s_getreg_b32 s24, hwreg(HW_REG_XCC_ID, 0, 1)
  s_cmp_lg_u32 s24, 0
  s_cbranch_scc1 L_store2
  s_branch L_store
L_end:
  s_endpgm
.p2align 12
L_sync:
  s_load_dwordx4 s[4:7], s[0:1], 8
  s_load_dwordx2 s[12:13], s[0:1], 40
  s_setprio 3
  v_and_b32 v0, 63, v0
  s_mul_i32 s32, s25, 4352
  s_add_u32 s33, s32, 69632
  s_mov_b32 s14, 0x10000000
  s_mov_b32 s15, 0x20000
  v_lshrrev_b32 v4, 5, v0
  v_mul_u32_u24 v4, 2176, v4
  v_lshl_add_u32 v4, v0, 2, v4
  s_mul_i32 s29, s25, 28
  v_lshrrev_b32 v5, 3, v0
  v_mul_u32_u24 v5, 416, v5
  v_lshl_add_u32 v5, v0, 2, v5
  v_add_u32 v5, s29, v5
  s_waitcnt lgkmcnt(0)
  buffer_load_dword v20, v4, s[12:15], s32 offen sc1
  buffer_load_dword v21, v4, s[12:15], s33 offen sc1
  s_mov_b64 exec, 0x7f7f
  global_load_dword v22, v5, s[4:5]
  global_load_dword v23, v5, s[6:7]
  s_mov_b64 exec, -1
  s_mov_b32 s8, 0xaaaaaaaa
  s_mov_b32 s9, s8
  s_lshl_b32 s24, s26, 1
  s_lshl_b64 s[34:35], 3, s24
  v_lshlrev_b32 v6, 3, v0
  v_lshlrev_b32 v8, 4, v0
  s_mov_b32 s36, s27
  s_mov_b32 s37, 0
  s_mov_b64 s[38:39], 0x7f
  s_barrier
L_phase:
  ds_read_b64 v[24:25], v6 offset:0
  ds_read_b64 v[26:27], v6 offset:512
  ds_read_b64 v[28:29], v6 offset:1024
  ds_read_b64 v[30:31], v6 offset:1536
  s_waitcnt vmcnt(0) lgkmcnt(0)
  v_pk_add_f32 v[24:25], v[24:25], v[26:27]
  v_pk_add_f32 v[28:29], v[28:29], v[30:31]
  v_not_b32 v33, v20
  v_pk_add_f32 v[24:25], v[24:25], v[28:29]
  v_cndmask_b32 v32, v24, v25, s[8:9]
  v_cndmask_b32 v34, v25, v24, s[8:9]
  s_nop 1
  v_add_f32_dpp v32, v34, v32 quad_perm:[1,0,3,2] row_mask:0xf bank_mask:0xf
  s_nop 1
  v_add_f32_dpp v32, v32, v32 quad_perm:[2,3,0,1] row_mask:0xf bank_mask:0xf
  s_nop 1
  v_add_f32_dpp v32, v32, v32 row_ror:4 row_mask:0xf bank_mask:0xf
  s_nop 1
  v_add_f32_dpp v32, v32, v32 row_ror:8 row_mask:0xf bank_mask:0xf
  v_mov_b32 v34, v32
  s_nop 1
  v_permlane16_swap_b32 v32, v34
  v_add_f32 v32, v32, v34
  v_mov_b32 v34, v32
  s_nop 1
  v_permlane32_swap_b32 v32, v34
  v_add_f32 v32, v32, v34
  v_bfi_b32 v32, 1, v33, v32
  s_mov_b64 exec, s[34:35]
  buffer_store_dword v32, v4, s[12:15], s32 offen
  s_mov_b64 exec, -1
  s_cmp_lg_u32 s37, 0
  s_cbranch_scc1 L_nob2
  s_barrier
L_nob2:
  s_movk_i32 s24, 32
  s_mov_b32 exec_hi, 0
L_poll1:
  buffer_load_dword v35, v4, s[12:15], s32 offen sc1
  s_sub_u32 s24, s24, 1
  s_waitcnt vmcnt(0)
  v_xor_b32 v36, v35, v33
  v_and_b32 v36, 1, v36
  v_cmp_ne_u32 vcc, 0, v36
  s_cbranch_vccz L_got
  s_cmp_lg_u32 s24, 0
  s_cbranch_scc1 L_poll1
  s_branch L_tier2
L_got:
  s_mov_b64 exec, -1
  v_and_b32 v35, -2, v35
  s_nop 1
  v_add_f32_dpp v35, v35, v35 quad_perm:[2,3,0,1] row_mask:0xf bank_mask:0xf
  s_nop 1
  v_add_f32_dpp v35, v35, v35 row_ror:4 row_mask:0xf bank_mask:0xf
  s_nop 1
  v_add_f32_dpp v35, v35, v35 row_ror:8 row_mask:0xf bank_mask:0xf
  v_mov_b32 v36, v35
  s_nop 1
  v_permlane16_swap_b32 v35, v36
  v_add_f32 v35, v35, v36
  s_nop 1
  v_mov_b32_dpp v12, v35 quad_perm:[0,0,2,2] row_mask:0xf bank_mask:0xf
  v_mov_b32_dpp v13, v35 quad_perm:[1,1,3,3] row_mask:0xf bank_mask:0xf
  v_mul_f32 v12, 0x36124925, v12
  v_mul_f32 v13, 0x36124925, v13
  v_fma_f32 v13, -v12, v12, v13
  v_max_f32 v13, 0, v13
  v_cvt_pk_bf16_f32 v14, v12, v12
  v_lshlrev_b32 v14, 16, v14
  v_sub_f32 v15, v12, v14
  v_fma_f32 v13, v15, v15, v13
  v_cvt_pk_bf16_f32 v13, v13, v13
  v_lshlrev_b32 v13, 16, v13
  v_add_f32 v13, 0x3727c5ac, v13
  v_cvt_pk_bf16_f32 v13, v13, v13
  v_lshlrev_b32 v13, 16, v13
  v_sqrt_f32 v13, v13
  v_lshlrev_b32 v24, 16, v22
  v_cvt_pk_bf16_f32 v13, v13, v13
  v_lshlrev_b32 v13, 16, v13
  v_rcp_f32 v13, v13
  v_and_b32 v26, 0xffff0000, v22
  v_lshlrev_b32 v25, 16, v23
  v_and_b32 v27, 0xffff0000, v23
  v_mul_f32 v24, v24, v13
  v_mul_f32 v26, v26, v13
  v_fma_f32 v25, -v14, v24, v25
  v_fma_f32 v27, -v14, v26, v27
  s_mov_b64 exec, s[38:39]
  ds_write_b128 v8, v[24:27] offset:4096
  s_mov_b64 exec, -1
  s_cmp_lg_u32 s37, 0
  s_waitcnt lgkmcnt(0)
  s_barrier
  s_cbranch_scc1 L_sdone
  s_mov_b32 s37, 1
  s_mov_b32 s32, s33
  s_add_u32 s36, s36, 14680064
  s_mov_b64 s[38:39], 0x7f00
  v_mov_b32 v20, v21
  v_add_u32 v6, 2048, v6
  s_branch L_phase
L_store:
  v_lshlrev_b32 v156, 16, v16
  v_and_b32 v157, s30, v16
  v_lshlrev_b32 v158, 16, v17
  v_and_b32 v159, s30, v17
  v_lshlrev_b32 v160, 16, v18
  v_and_b32 v161, s30, v18
  v_lshlrev_b32 v162, 16, v19
  v_and_b32 v163, s30, v19
  s_barrier
  ds_read_b128 v[128:131], v5 offset:4096
  ds_read_b128 v[132:135], v5 offset:4112
  ds_read_b128 v[136:139], v5 offset:4128
  ds_read_b128 v[140:143], v5 offset:4144
  ds_read_b128 v[144:147], v5 offset:4160
  ds_read_b128 v[148:151], v5 offset:4176
  ds_read_b128 v[152:155], v5 offset:4192
  s_waitcnt lgkmcnt(6)
  v_pk_fma_f32 v[156:157], v[156:157], v[128:129], v[128:129] op_sel:[0,0,1] op_sel_hi:[1,0,1]
  v_pk_fma_f32 v[158:159], v[158:159], v[128:129], v[128:129] op_sel:[0,0,1] op_sel_hi:[1,0,1]
  v_pk_fma_f32 v[160:161], v[160:161], v[128:129], v[128:129] op_sel:[0,0,1] op_sel_hi:[1,0,1]
  v_pk_fma_f32 v[162:163], v[162:163], v[128:129], v[128:129] op_sel:[0,0,1] op_sel_hi:[1,0,1]
  v_cvt_pk_bf16_f32 v16, v156, v157
  v_cvt_pk_bf16_f32 v17, v158, v159
  v_cvt_pk_bf16_f32 v18, v160, v161
  v_cvt_pk_bf16_f32 v19, v162, v163
  buffer_store_dwordx4 v[16:19], v2, s[20:23], s29 offen nt
  s_add_u32 s29, s29, s33
  v_lshlrev_b32 v156, 16, v20
  v_and_b32 v157, s30, v20
  v_lshlrev_b32 v158, 16, v21
  v_and_b32 v159, s30, v21
  v_lshlrev_b32 v160, 16, v22
  v_and_b32 v161, s30, v22
  v_lshlrev_b32 v162, 16, v23
  v_and_b32 v163, s30, v23
  v_pk_fma_f32 v[156:157], v[156:157], v[130:131], v[130:131] op_sel:[0,0,1] op_sel_hi:[1,0,1]
  v_pk_fma_f32 v[158:159], v[158:159], v[130:131], v[130:131] op_sel:[0,0,1] op_sel_hi:[1,0,1]
  v_pk_fma_f32 v[160:161], v[160:161], v[130:131], v[130:131] op_sel:[0,0,1] op_sel_hi:[1,0,1]
  v_pk_fma_f32 v[162:163], v[162:163], v[130:131], v[130:131] op_sel:[0,0,1] op_sel_hi:[1,0,1]
  v_cvt_pk_bf16_f32 v20, v156, v157
  v_cvt_pk_bf16_f32 v21, v158, v159
  v_cvt_pk_bf16_f32 v22, v160, v161
  v_cvt_pk_bf16_f32 v23, v162, v163
  buffer_store_dwordx4 v[20:23], v3, s[20:23], s29 offen nt
  s_add_u32 s29, s29, s33
  v_lshlrev_b32 v156, 16, v24
  v_and_b32 v157, s30, v24
  v_lshlrev_b32 v158, 16, v25
  v_and_b32 v159, s30, v25
  v_lshlrev_b32 v160, 16, v26
  v_and_b32 v161, s30, v26
  v_lshlrev_b32 v162, 16, v27
  v_and_b32 v163, s30, v27
  s_waitcnt lgkmcnt(5)
  v_pk_fma_f32 v[156:157], v[156:157], v[132:133], v[132:133] op_sel:[0,0,1] op_sel_hi:[1,0,1]
  v_pk_fma_f32 v[158:159], v[158:159], v[132:133], v[132:133] op_sel:[0,0,1] op_sel_hi:[1,0,1]
  v_pk_fma_f32 v[160:161], v[160:161], v[132:133], v[132:133] op_sel:[0,0,1] op_sel_hi:[1,0,1]
  v_pk_fma_f32 v[162:163], v[162:163], v[132:133], v[132:133] op_sel:[0,0,1] op_sel_hi:[1,0,1]
  v_cvt_pk_bf16_f32 v24, v156, v157
  v_cvt_pk_bf16_f32 v25, v158, v159
  v_cvt_pk_bf16_f32 v26, v160, v161
  v_cvt_pk_bf16_f32 v27, v162, v163
  buffer_store_dwordx4 v[24:27], v2, s[20:23], s29 offen sc1
  s_add_u32 s29, s29, s33
  v_lshlrev_b32 v156, 16, v28
  v_and_b32 v157, s30, v28
  v_lshlrev_b32 v158, 16, v29
  v_and_b32 v159, s30, v29
  v_lshlrev_b32 v160, 16, v30
  v_and_b32 v161, s30, v30
  v_lshlrev_b32 v162, 16, v31
  v_and_b32 v163, s30, v31
  v_pk_fma_f32 v[156:157], v[156:157], v[134:135], v[134:135] op_sel:[0,0,1] op_sel_hi:[1,0,1]
  v_pk_fma_f32 v[158:159], v[158:159], v[134:135], v[134:135] op_sel:[0,0,1] op_sel_hi:[1,0,1]
  v_pk_fma_f32 v[160:161], v[160:161], v[134:135], v[134:135] op_sel:[0,0,1] op_sel_hi:[1,0,1]
  v_pk_fma_f32 v[162:163], v[162:163], v[134:135], v[134:135] op_sel:[0,0,1] op_sel_hi:[1,0,1]
  v_cvt_pk_bf16_f32 v28, v156, v157
  v_cvt_pk_bf16_f32 v29, v158, v159
  v_cvt_pk_bf16_f32 v30, v160, v161
  v_cvt_pk_bf16_f32 v31, v162, v163
  buffer_store_dwordx4 v[28:31], v3, s[20:23], s29 offen sc1
  s_add_u32 s29, s29, s33
  v_lshlrev_b32 v156, 16, v32
  v_and_b32 v157, s30, v32
  v_lshlrev_b32 v158, 16, v33
  v_and_b32 v159, s30, v33
  v_lshlrev_b32 v160, 16, v34
  v_and_b32 v161, s30, v34
  v_lshlrev_b32 v162, 16, v35
  v_and_b32 v163, s30, v35
  s_waitcnt lgkmcnt(4)
  v_pk_fma_f32 v[156:157], v[156:157], v[136:137], v[136:137] op_sel:[0,0,1] op_sel_hi:[1,0,1]
  v_pk_fma_f32 v[158:159], v[158:159], v[136:137], v[136:137] op_sel:[0,0,1] op_sel_hi:[1,0,1]
  v_pk_fma_f32 v[160:161], v[160:161], v[136:137], v[136:137] op_sel:[0,0,1] op_sel_hi:[1,0,1]
  v_pk_fma_f32 v[162:163], v[162:163], v[136:137], v[136:137] op_sel:[0,0,1] op_sel_hi:[1,0,1]
  v_cvt_pk_bf16_f32 v32, v156, v157
  v_cvt_pk_bf16_f32 v33, v158, v159
  v_cvt_pk_bf16_f32 v34, v160, v161
  v_cvt_pk_bf16_f32 v35, v162, v163
  buffer_store_dwordx4 v[32:35], v2, s[20:23], s29 offen sc1
  s_add_u32 s29, s29, s33
  v_lshlrev_b32 v156, 16, v36
  v_and_b32 v157, s30, v36
  v_lshlrev_b32 v158, 16, v37
  v_and_b32 v159, s30, v37
  v_lshlrev_b32 v160, 16, v38
  v_and_b32 v161, s30, v38
  v_lshlrev_b32 v162, 16, v39
  v_and_b32 v163, s30, v39
  v_pk_fma_f32 v[156:157], v[156:157], v[138:139], v[138:139] op_sel:[0,0,1] op_sel_hi:[1,0,1]
  v_pk_fma_f32 v[158:159], v[158:159], v[138:139], v[138:139] op_sel:[0,0,1] op_sel_hi:[1,0,1]
  v_pk_fma_f32 v[160:161], v[160:161], v[138:139], v[138:139] op_sel:[0,0,1] op_sel_hi:[1,0,1]
  v_pk_fma_f32 v[162:163], v[162:163], v[138:139], v[138:139] op_sel:[0,0,1] op_sel_hi:[1,0,1]
  v_cvt_pk_bf16_f32 v36, v156, v157
  v_cvt_pk_bf16_f32 v37, v158, v159
  v_cvt_pk_bf16_f32 v38, v160, v161
  v_cvt_pk_bf16_f32 v39, v162, v163
  buffer_store_dwordx4 v[36:39], v3, s[20:23], s29 offen sc1
  s_add_u32 s29, s29, s33
  v_lshlrev_b32 v156, 16, v40
  v_and_b32 v157, s30, v40
  v_lshlrev_b32 v158, 16, v41
  v_and_b32 v159, s30, v41
  v_lshlrev_b32 v160, 16, v42
  v_and_b32 v161, s30, v42
  v_lshlrev_b32 v162, 16, v43
  v_and_b32 v163, s30, v43
  s_waitcnt lgkmcnt(3)
  v_pk_fma_f32 v[156:157], v[156:157], v[140:141], v[140:141] op_sel:[0,0,1] op_sel_hi:[1,0,1]
  v_pk_fma_f32 v[158:159], v[158:159], v[140:141], v[140:141] op_sel:[0,0,1] op_sel_hi:[1,0,1]
  v_pk_fma_f32 v[160:161], v[160:161], v[140:141], v[140:141] op_sel:[0,0,1] op_sel_hi:[1,0,1]
  v_pk_fma_f32 v[162:163], v[162:163], v[140:141], v[140:141] op_sel:[0,0,1] op_sel_hi:[1,0,1]
  v_cvt_pk_bf16_f32 v40, v156, v157
  v_cvt_pk_bf16_f32 v41, v158, v159
  v_cvt_pk_bf16_f32 v42, v160, v161
  v_cvt_pk_bf16_f32 v43, v162, v163
  buffer_store_dwordx4 v[40:43], v2, s[20:23], s29 offen sc1
  s_add_u32 s29, s29, s33
  v_lshlrev_b32 v156, 16, v44
  v_and_b32 v157, s30, v44
  v_lshlrev_b32 v158, 16, v45
  v_and_b32 v159, s30, v45
  v_lshlrev_b32 v160, 16, v46
  v_and_b32 v161, s30, v46
  v_lshlrev_b32 v162, 16, v47
  v_and_b32 v163, s30, v47
  v_pk_fma_f32 v[156:157], v[156:157], v[142:143], v[142:143] op_sel:[0,0,1] op_sel_hi:[1,0,1]
  v_pk_fma_f32 v[158:159], v[158:159], v[142:143], v[142:143] op_sel:[0,0,1] op_sel_hi:[1,0,1]
  v_pk_fma_f32 v[160:161], v[160:161], v[142:143], v[142:143] op_sel:[0,0,1] op_sel_hi:[1,0,1]
  v_pk_fma_f32 v[162:163], v[162:163], v[142:143], v[142:143] op_sel:[0,0,1] op_sel_hi:[1,0,1]
  v_cvt_pk_bf16_f32 v44, v156, v157
  v_cvt_pk_bf16_f32 v45, v158, v159
  v_cvt_pk_bf16_f32 v46, v160, v161
  v_cvt_pk_bf16_f32 v47, v162, v163
  buffer_store_dwordx4 v[44:47], v3, s[20:23], s29 offen sc1
  s_add_u32 s29, s29, s33
  v_lshlrev_b32 v156, 16, v48
  v_and_b32 v157, s30, v48
  v_lshlrev_b32 v158, 16, v49
  v_and_b32 v159, s30, v49
  v_lshlrev_b32 v160, 16, v50
  v_and_b32 v161, s30, v50
  v_lshlrev_b32 v162, 16, v51
  v_and_b32 v163, s30, v51
  s_waitcnt lgkmcnt(2)
  v_pk_fma_f32 v[156:157], v[156:157], v[144:145], v[144:145] op_sel:[0,0,1] op_sel_hi:[1,0,1]
  v_pk_fma_f32 v[158:159], v[158:159], v[144:145], v[144:145] op_sel:[0,0,1] op_sel_hi:[1,0,1]
  v_pk_fma_f32 v[160:161], v[160:161], v[144:145], v[144:145] op_sel:[0,0,1] op_sel_hi:[1,0,1]
  v_pk_fma_f32 v[162:163], v[162:163], v[144:145], v[144:145] op_sel:[0,0,1] op_sel_hi:[1,0,1]
  v_cvt_pk_bf16_f32 v48, v156, v157
  v_cvt_pk_bf16_f32 v49, v158, v159
  v_cvt_pk_bf16_f32 v50, v160, v161
  v_cvt_pk_bf16_f32 v51, v162, v163
  buffer_store_dwordx4 v[48:51], v2, s[20:23], s29 offen sc1
  s_add_u32 s29, s29, s33
  v_lshlrev_b32 v156, 16, v52
  v_and_b32 v157, s30, v52
  v_lshlrev_b32 v158, 16, v53
  v_and_b32 v159, s30, v53
  v_lshlrev_b32 v160, 16, v54
  v_and_b32 v161, s30, v54
  v_lshlrev_b32 v162, 16, v55
  v_and_b32 v163, s30, v55
  v_pk_fma_f32 v[156:157], v[156:157], v[146:147], v[146:147] op_sel:[0,0,1] op_sel_hi:[1,0,1]
  v_pk_fma_f32 v[158:159], v[158:159], v[146:147], v[146:147] op_sel:[0,0,1] op_sel_hi:[1,0,1]
  v_pk_fma_f32 v[160:161], v[160:161], v[146:147], v[146:147] op_sel:[0,0,1] op_sel_hi:[1,0,1]
  v_pk_fma_f32 v[162:163], v[162:163], v[146:147], v[146:147] op_sel:[0,0,1] op_sel_hi:[1,0,1]
  v_cvt_pk_bf16_f32 v52, v156, v157
  v_cvt_pk_bf16_f32 v53, v158, v159
  v_cvt_pk_bf16_f32 v54, v160, v161
  v_cvt_pk_bf16_f32 v55, v162, v163
  buffer_store_dwordx4 v[52:55], v3, s[20:23], s29 offen sc1
  s_add_u32 s29, s29, s33
  v_lshlrev_b32 v156, 16, v56
  v_and_b32 v157, s30, v56
  v_lshlrev_b32 v158, 16, v57
  v_and_b32 v159, s30, v57
  v_lshlrev_b32 v160, 16, v58
  v_and_b32 v161, s30, v58
  v_lshlrev_b32 v162, 16, v59
  v_and_b32 v163, s30, v59
  s_waitcnt lgkmcnt(1)
  v_pk_fma_f32 v[156:157], v[156:157], v[148:149], v[148:149] op_sel:[0,0,1] op_sel_hi:[1,0,1]
  v_pk_fma_f32 v[158:159], v[158:159], v[148:149], v[148:149] op_sel:[0,0,1] op_sel_hi:[1,0,1]
  v_pk_fma_f32 v[160:161], v[160:161], v[148:149], v[148:149] op_sel:[0,0,1] op_sel_hi:[1,0,1]
  v_pk_fma_f32 v[162:163], v[162:163], v[148:149], v[148:149] op_sel:[0,0,1] op_sel_hi:[1,0,1]
  v_cvt_pk_bf16_f32 v56, v156, v157
  v_cvt_pk_bf16_f32 v57, v158, v159
  v_cvt_pk_bf16_f32 v58, v160, v161
  v_cvt_pk_bf16_f32 v59, v162, v163
  buffer_store_dwordx4 v[56:59], v2, s[20:23], s29 offen sc1
  s_add_u32 s29, s29, s33
  v_lshlrev_b32 v156, 16, v60
  v_and_b32 v157, s30, v60
  v_lshlrev_b32 v158, 16, v61
  v_and_b32 v159, s30, v61
  v_lshlrev_b32 v160, 16, v62
  v_and_b32 v161, s30, v62
  v_lshlrev_b32 v162, 16, v63
  v_and_b32 v163, s30, v63
  v_pk_fma_f32 v[156:157], v[156:157], v[150:151], v[150:151] op_sel:[0,0,1] op_sel_hi:[1,0,1]
  v_pk_fma_f32 v[158:159], v[158:159], v[150:151], v[150:151] op_sel:[0,0,1] op_sel_hi:[1,0,1]
  v_pk_fma_f32 v[160:161], v[160:161], v[150:151], v[150:151] op_sel:[0,0,1] op_sel_hi:[1,0,1]
  v_pk_fma_f32 v[162:163], v[162:163], v[150:151], v[150:151] op_sel:[0,0,1] op_sel_hi:[1,0,1]
  v_cvt_pk_bf16_f32 v60, v156, v157
  v_cvt_pk_bf16_f32 v61, v158, v159
  v_cvt_pk_bf16_f32 v62, v160, v161
  v_cvt_pk_bf16_f32 v63, v162, v163
  buffer_store_dwordx4 v[60:63], v3, s[20:23], s29 offen sc1
  s_add_u32 s29, s29, s33
  v_lshlrev_b32 v156, 16, v64
  v_and_b32 v157, s30, v64
  v_lshlrev_b32 v158, 16, v65
  v_and_b32 v159, s30, v65
  v_lshlrev_b32 v160, 16, v66
  v_and_b32 v161, s30, v66
  v_lshlrev_b32 v162, 16, v67
  v_and_b32 v163, s30, v67
  s_waitcnt lgkmcnt(0)
  v_pk_fma_f32 v[156:157], v[156:157], v[152:153], v[152:153] op_sel:[0,0,1] op_sel_hi:[1,0,1]
  v_pk_fma_f32 v[158:159], v[158:159], v[152:153], v[152:153] op_sel:[0,0,1] op_sel_hi:[1,0,1]
  v_pk_fma_f32 v[160:161], v[160:161], v[152:153], v[152:153] op_sel:[0,0,1] op_sel_hi:[1,0,1]
  v_pk_fma_f32 v[162:163], v[162:163], v[152:153], v[152:153] op_sel:[0,0,1] op_sel_hi:[1,0,1]
  v_cvt_pk_bf16_f32 v64, v156, v157
  v_cvt_pk_bf16_f32 v65, v158, v159
  v_cvt_pk_bf16_f32 v66, v160, v161
  v_cvt_pk_bf16_f32 v67, v162, v163
  buffer_store_dwordx4 v[64:67], v2, s[20:23], s29 offen sc1
  s_add_u32 s29, s29, s33
  v_lshlrev_b32 v156, 16, v68
  v_and_b32 v157, s30, v68
  v_lshlrev_b32 v158, 16, v69
  v_and_b32 v159, s30, v69
  v_lshlrev_b32 v160, 16, v70
  v_and_b32 v161, s30, v70
  v_lshlrev_b32 v162, 16, v71
  v_and_b32 v163, s30, v71
  v_pk_fma_f32 v[156:157], v[156:157], v[154:155], v[154:155] op_sel:[0,0,1] op_sel_hi:[1,0,1]
  v_pk_fma_f32 v[158:159], v[158:159], v[154:155], v[154:155] op_sel:[0,0,1] op_sel_hi:[1,0,1]
  v_pk_fma_f32 v[160:161], v[160:161], v[154:155], v[154:155] op_sel:[0,0,1] op_sel_hi:[1,0,1]
  v_pk_fma_f32 v[162:163], v[162:163], v[154:155], v[154:155] op_sel:[0,0,1] op_sel_hi:[1,0,1]
  v_cvt_pk_bf16_f32 v68, v156, v157
  v_cvt_pk_bf16_f32 v69, v158, v159
  v_cvt_pk_bf16_f32 v70, v160, v161
  v_cvt_pk_bf16_f32 v71, v162, v163
  buffer_store_dwordx4 v[68:71], v3, s[20:23], s29 offen sc1
  s_add_u32 s29, s29, 13828096
  v_lshlrev_b32 v156, 16, v72
  v_and_b32 v157, s30, v72
  v_lshlrev_b32 v158, 16, v73
  v_and_b32 v159, s30, v73
  v_lshlrev_b32 v160, 16, v74
  v_and_b32 v161, s30, v74
  v_lshlrev_b32 v162, 16, v75
  v_and_b32 v163, s30, v75
  s_barrier
  ds_read_b128 v[128:131], v5 offset:4224
  ds_read_b128 v[132:135], v5 offset:4240
  ds_read_b128 v[136:139], v5 offset:4256
  ds_read_b128 v[140:143], v5 offset:4272
  ds_read_b128 v[144:147], v5 offset:4288
  ds_read_b128 v[148:151], v5 offset:4304
  ds_read_b128 v[152:155], v5 offset:4320
  s_waitcnt lgkmcnt(6)
  v_pk_fma_f32 v[156:157], v[156:157], v[128:129], v[128:129] op_sel:[0,0,1] op_sel_hi:[1,0,1]
  v_pk_fma_f32 v[158:159], v[158:159], v[128:129], v[128:129] op_sel:[0,0,1] op_sel_hi:[1,0,1]
  v_pk_fma_f32 v[160:161], v[160:161], v[128:129], v[128:129] op_sel:[0,0,1] op_sel_hi:[1,0,1]
  v_pk_fma_f32 v[162:163], v[162:163], v[128:129], v[128:129] op_sel:[0,0,1] op_sel_hi:[1,0,1]
  v_cvt_pk_bf16_f32 v72, v156, v157
  v_cvt_pk_bf16_f32 v73, v158, v159
  v_cvt_pk_bf16_f32 v74, v160, v161
  v_cvt_pk_bf16_f32 v75, v162, v163
  buffer_store_dwordx4 v[72:75], v2, s[20:23], s29 offen sc1
  s_add_u32 s29, s29, s33
  v_lshlrev_b32 v156, 16, v76
  v_and_b32 v157, s30, v76
  v_lshlrev_b32 v158, 16, v77
  v_and_b32 v159, s30, v77
  v_lshlrev_b32 v160, 16, v78
  v_and_b32 v161, s30, v78
  v_lshlrev_b32 v162, 16, v79
  v_and_b32 v163, s30, v79
  v_pk_fma_f32 v[156:157], v[156:157], v[130:131], v[130:131] op_sel:[0,0,1] op_sel_hi:[1,0,1]
  v_pk_fma_f32 v[158:159], v[158:159], v[130:131], v[130:131] op_sel:[0,0,1] op_sel_hi:[1,0,1]
  v_pk_fma_f32 v[160:161], v[160:161], v[130:131], v[130:131] op_sel:[0,0,1] op_sel_hi:[1,0,1]
  v_pk_fma_f32 v[162:163], v[162:163], v[130:131], v[130:131] op_sel:[0,0,1] op_sel_hi:[1,0,1]
  v_cvt_pk_bf16_f32 v76, v156, v157
  v_cvt_pk_bf16_f32 v77, v158, v159
  v_cvt_pk_bf16_f32 v78, v160, v161
  v_cvt_pk_bf16_f32 v79, v162, v163
  buffer_store_dwordx4 v[76:79], v3, s[20:23], s29 offen sc1
  s_add_u32 s29, s29, s33
  v_lshlrev_b32 v156, 16, v80
  v_and_b32 v157, s30, v80
  v_lshlrev_b32 v158, 16, v81
  v_and_b32 v159, s30, v81
  v_lshlrev_b32 v160, 16, v82
  v_and_b32 v161, s30, v82
  v_lshlrev_b32 v162, 16, v83
  v_and_b32 v163, s30, v83
  s_waitcnt lgkmcnt(5)
  v_pk_fma_f32 v[156:157], v[156:157], v[132:133], v[132:133] op_sel:[0,0,1] op_sel_hi:[1,0,1]
  v_pk_fma_f32 v[158:159], v[158:159], v[132:133], v[132:133] op_sel:[0,0,1] op_sel_hi:[1,0,1]
  v_pk_fma_f32 v[160:161], v[160:161], v[132:133], v[132:133] op_sel:[0,0,1] op_sel_hi:[1,0,1]
  v_pk_fma_f32 v[162:163], v[162:163], v[132:133], v[132:133] op_sel:[0,0,1] op_sel_hi:[1,0,1]
  v_cvt_pk_bf16_f32 v80, v156, v157
  v_cvt_pk_bf16_f32 v81, v158, v159
  v_cvt_pk_bf16_f32 v82, v160, v161
  v_cvt_pk_bf16_f32 v83, v162, v163
  buffer_store_dwordx4 v[80:83], v2, s[20:23], s29 offen nt
  s_add_u32 s29, s29, s33
  v_lshlrev_b32 v156, 16, v84
  v_and_b32 v157, s30, v84
  v_lshlrev_b32 v158, 16, v85
  v_and_b32 v159, s30, v85
  v_lshlrev_b32 v160, 16, v86
  v_and_b32 v161, s30, v86
  v_lshlrev_b32 v162, 16, v87
  v_and_b32 v163, s30, v87
  v_pk_fma_f32 v[156:157], v[156:157], v[134:135], v[134:135] op_sel:[0,0,1] op_sel_hi:[1,0,1]
  v_pk_fma_f32 v[158:159], v[158:159], v[134:135], v[134:135] op_sel:[0,0,1] op_sel_hi:[1,0,1]
  v_pk_fma_f32 v[160:161], v[160:161], v[134:135], v[134:135] op_sel:[0,0,1] op_sel_hi:[1,0,1]
  v_pk_fma_f32 v[162:163], v[162:163], v[134:135], v[134:135] op_sel:[0,0,1] op_sel_hi:[1,0,1]
  v_cvt_pk_bf16_f32 v84, v156, v157
  v_cvt_pk_bf16_f32 v85, v158, v159
  v_cvt_pk_bf16_f32 v86, v160, v161
  v_cvt_pk_bf16_f32 v87, v162, v163
  buffer_store_dwordx4 v[84:87], v3, s[20:23], s29 offen nt
  s_add_u32 s29, s29, s33
  v_lshlrev_b32 v156, 16, v88
  v_and_b32 v157, s30, v88
  v_lshlrev_b32 v158, 16, v89
  v_and_b32 v159, s30, v89
  v_lshlrev_b32 v160, 16, v90
  v_and_b32 v161, s30, v90
  v_lshlrev_b32 v162, 16, v91
  v_and_b32 v163, s30, v91
  s_waitcnt lgkmcnt(4)
  v_pk_fma_f32 v[156:157], v[156:157], v[136:137], v[136:137] op_sel:[0,0,1] op_sel_hi:[1,0,1]
  v_pk_fma_f32 v[158:159], v[158:159], v[136:137], v[136:137] op_sel:[0,0,1] op_sel_hi:[1,0,1]
  v_pk_fma_f32 v[160:161], v[160:161], v[136:137], v[136:137] op_sel:[0,0,1] op_sel_hi:[1,0,1]
  v_pk_fma_f32 v[162:163], v[162:163], v[136:137], v[136:137] op_sel:[0,0,1] op_sel_hi:[1,0,1]
  v_cvt_pk_bf16_f32 v88, v156, v157
  v_cvt_pk_bf16_f32 v89, v158, v159
  v_cvt_pk_bf16_f32 v90, v160, v161
  v_cvt_pk_bf16_f32 v91, v162, v163
  buffer_store_dwordx4 v[88:91], v2, s[20:23], s29 offen nt
  s_add_u32 s29, s29, s33
  v_lshlrev_b32 v156, 16, v92
  v_and_b32 v157, s30, v92
  v_lshlrev_b32 v158, 16, v93
  v_and_b32 v159, s30, v93
  v_lshlrev_b32 v160, 16, v94
  v_and_b32 v161, s30, v94
  v_lshlrev_b32 v162, 16, v95
  v_and_b32 v163, s30, v95
  v_pk_fma_f32 v[156:157], v[156:157], v[138:139], v[138:139] op_sel:[0,0,1] op_sel_hi:[1,0,1]
  v_pk_fma_f32 v[158:159], v[158:159], v[138:139], v[138:139] op_sel:[0,0,1] op_sel_hi:[1,0,1]
  v_pk_fma_f32 v[160:161], v[160:161], v[138:139], v[138:139] op_sel:[0,0,1] op_sel_hi:[1,0,1]
  v_pk_fma_f32 v[162:163], v[162:163], v[138:139], v[138:139] op_sel:[0,0,1] op_sel_hi:[1,0,1]
  v_cvt_pk_bf16_f32 v92, v156, v157
  v_cvt_pk_bf16_f32 v93, v158, v159
  v_cvt_pk_bf16_f32 v94, v160, v161
  v_cvt_pk_bf16_f32 v95, v162, v163
  buffer_store_dwordx4 v[92:95], v3, s[20:23], s29 offen nt
  s_add_u32 s29, s29, s33
  v_lshlrev_b32 v156, 16, v96
  v_and_b32 v157, s30, v96
  v_lshlrev_b32 v158, 16, v97
  v_and_b32 v159, s30, v97
  v_lshlrev_b32 v160, 16, v98
  v_and_b32 v161, s30, v98
  v_lshlrev_b32 v162, 16, v99
  v_and_b32 v163, s30, v99
  s_waitcnt lgkmcnt(3)
  v_pk_fma_f32 v[156:157], v[156:157], v[140:141], v[140:141] op_sel:[0,0,1] op_sel_hi:[1,0,1]
  v_pk_fma_f32 v[158:159], v[158:159], v[140:141], v[140:141] op_sel:[0,0,1] op_sel_hi:[1,0,1]
  v_pk_fma_f32 v[160:161], v[160:161], v[140:141], v[140:141] op_sel:[0,0,1] op_sel_hi:[1,0,1]
  v_pk_fma_f32 v[162:163], v[162:163], v[140:141], v[140:141] op_sel:[0,0,1] op_sel_hi:[1,0,1]
  v_cvt_pk_bf16_f32 v96, v156, v157
  v_cvt_pk_bf16_f32 v97, v158, v159
  v_cvt_pk_bf16_f32 v98, v160, v161
  v_cvt_pk_bf16_f32 v99, v162, v163
  buffer_store_dwordx4 v[96:99], v2, s[20:23], s29 offen nt
  s_add_u32 s29, s29, s33
  v_lshlrev_b32 v156, 16, v100
  v_and_b32 v157, s30, v100
  v_lshlrev_b32 v158, 16, v101
  v_and_b32 v159, s30, v101
  v_lshlrev_b32 v160, 16, v102
  v_and_b32 v161, s30, v102
  v_lshlrev_b32 v162, 16, v103
  v_and_b32 v163, s30, v103
  v_pk_fma_f32 v[156:157], v[156:157], v[142:143], v[142:143] op_sel:[0,0,1] op_sel_hi:[1,0,1]
  v_pk_fma_f32 v[158:159], v[158:159], v[142:143], v[142:143] op_sel:[0,0,1] op_sel_hi:[1,0,1]
  v_pk_fma_f32 v[160:161], v[160:161], v[142:143], v[142:143] op_sel:[0,0,1] op_sel_hi:[1,0,1]
  v_pk_fma_f32 v[162:163], v[162:163], v[142:143], v[142:143] op_sel:[0,0,1] op_sel_hi:[1,0,1]
  v_cvt_pk_bf16_f32 v100, v156, v157
  v_cvt_pk_bf16_f32 v101, v158, v159
  v_cvt_pk_bf16_f32 v102, v160, v161
  v_cvt_pk_bf16_f32 v103, v162, v163
  buffer_store_dwordx4 v[100:103], v3, s[20:23], s29 offen nt
  s_add_u32 s29, s29, s33
  v_lshlrev_b32 v156, 16, v104
  v_and_b32 v157, s30, v104
  v_lshlrev_b32 v158, 16, v105
  v_and_b32 v159, s30, v105
  v_lshlrev_b32 v160, 16, v106
  v_and_b32 v161, s30, v106
  v_lshlrev_b32 v162, 16, v107
  v_and_b32 v163, s30, v107
  s_waitcnt lgkmcnt(2)
  v_pk_fma_f32 v[156:157], v[156:157], v[144:145], v[144:145] op_sel:[0,0,1] op_sel_hi:[1,0,1]
  v_pk_fma_f32 v[158:159], v[158:159], v[144:145], v[144:145] op_sel:[0,0,1] op_sel_hi:[1,0,1]
  v_pk_fma_f32 v[160:161], v[160:161], v[144:145], v[144:145] op_sel:[0,0,1] op_sel_hi:[1,0,1]
  v_pk_fma_f32 v[162:163], v[162:163], v[144:145], v[144:145] op_sel:[0,0,1] op_sel_hi:[1,0,1]
  v_cvt_pk_bf16_f32 v104, v156, v157
  v_cvt_pk_bf16_f32 v105, v158, v159
  v_cvt_pk_bf16_f32 v106, v160, v161
  v_cvt_pk_bf16_f32 v107, v162, v163
  buffer_store_dwordx4 v[104:107], v2, s[20:23], s29 offen nt
  s_add_u32 s29, s29, s33
  v_lshlrev_b32 v156, 16, v108
  v_and_b32 v157, s30, v108
  v_lshlrev_b32 v158, 16, v109
  v_and_b32 v159, s30, v109
  v_lshlrev_b32 v160, 16, v110
  v_and_b32 v161, s30, v110
  v_lshlrev_b32 v162, 16, v111
  v_and_b32 v163, s30, v111
  v_pk_fma_f32 v[156:157], v[156:157], v[146:147], v[146:147] op_sel:[0,0,1] op_sel_hi:[1,0,1]
  v_pk_fma_f32 v[158:159], v[158:159], v[146:147], v[146:147] op_sel:[0,0,1] op_sel_hi:[1,0,1]
  v_pk_fma_f32 v[160:161], v[160:161], v[146:147], v[146:147] op_sel:[0,0,1] op_sel_hi:[1,0,1]
  v_pk_fma_f32 v[162:163], v[162:163], v[146:147], v[146:147] op_sel:[0,0,1] op_sel_hi:[1,0,1]
  v_cvt_pk_bf16_f32 v108, v156, v157
  v_cvt_pk_bf16_f32 v109, v158, v159
  v_cvt_pk_bf16_f32 v110, v160, v161
  v_cvt_pk_bf16_f32 v111, v162, v163
  buffer_store_dwordx4 v[108:111], v3, s[20:23], s29 offen nt
  s_add_u32 s29, s29, s33
  v_lshlrev_b32 v156, 16, v112
  v_and_b32 v157, s30, v112
  v_lshlrev_b32 v158, 16, v113
  v_and_b32 v159, s30, v113
  v_lshlrev_b32 v160, 16, v114
  v_and_b32 v161, s30, v114
  v_lshlrev_b32 v162, 16, v115
  v_and_b32 v163, s30, v115
  s_waitcnt lgkmcnt(1)
  v_pk_fma_f32 v[156:157], v[156:157], v[148:149], v[148:149] op_sel:[0,0,1] op_sel_hi:[1,0,1]
  v_pk_fma_f32 v[158:159], v[158:159], v[148:149], v[148:149] op_sel:[0,0,1] op_sel_hi:[1,0,1]
  v_pk_fma_f32 v[160:161], v[160:161], v[148:149], v[148:149] op_sel:[0,0,1] op_sel_hi:[1,0,1]
  v_pk_fma_f32 v[162:163], v[162:163], v[148:149], v[148:149] op_sel:[0,0,1] op_sel_hi:[1,0,1]
  v_cvt_pk_bf16_f32 v112, v156, v157
  v_cvt_pk_bf16_f32 v113, v158, v159
  v_cvt_pk_bf16_f32 v114, v160, v161
  v_cvt_pk_bf16_f32 v115, v162, v163
  buffer_store_dwordx4 v[112:115], v2, s[20:23], s29 offen nt
  s_add_u32 s29, s29, s33
  v_lshlrev_b32 v156, 16, v116
  v_and_b32 v157, s30, v116
  v_lshlrev_b32 v158, 16, v117
  v_and_b32 v159, s30, v117
  v_lshlrev_b32 v160, 16, v118
  v_and_b32 v161, s30, v118
  v_lshlrev_b32 v162, 16, v119
  v_and_b32 v163, s30, v119
  v_pk_fma_f32 v[156:157], v[156:157], v[150:151], v[150:151] op_sel:[0,0,1] op_sel_hi:[1,0,1]
  v_pk_fma_f32 v[158:159], v[158:159], v[150:151], v[150:151] op_sel:[0,0,1] op_sel_hi:[1,0,1]
  v_pk_fma_f32 v[160:161], v[160:161], v[150:151], v[150:151] op_sel:[0,0,1] op_sel_hi:[1,0,1]
  v_pk_fma_f32 v[162:163], v[162:163], v[150:151], v[150:151] op_sel:[0,0,1] op_sel_hi:[1,0,1]
  v_cvt_pk_bf16_f32 v116, v156, v157
  v_cvt_pk_bf16_f32 v117, v158, v159
  v_cvt_pk_bf16_f32 v118, v160, v161
  v_cvt_pk_bf16_f32 v119, v162, v163
  buffer_store_dwordx4 v[116:119], v3, s[20:23], s29 offen nt
  s_add_u32 s29, s29, s33
  v_lshlrev_b32 v156, 16, v120
  v_and_b32 v157, s30, v120
  v_lshlrev_b32 v158, 16, v121
  v_and_b32 v159, s30, v121
  v_lshlrev_b32 v160, 16, v122
  v_and_b32 v161, s30, v122
  v_lshlrev_b32 v162, 16, v123
  v_and_b32 v163, s30, v123
  s_waitcnt lgkmcnt(0)
  v_pk_fma_f32 v[156:157], v[156:157], v[152:153], v[152:153] op_sel:[0,0,1] op_sel_hi:[1,0,1]
  v_pk_fma_f32 v[158:159], v[158:159], v[152:153], v[152:153] op_sel:[0,0,1] op_sel_hi:[1,0,1]
  v_pk_fma_f32 v[160:161], v[160:161], v[152:153], v[152:153] op_sel:[0,0,1] op_sel_hi:[1,0,1]
  v_pk_fma_f32 v[162:163], v[162:163], v[152:153], v[152:153] op_sel:[0,0,1] op_sel_hi:[1,0,1]
  v_cvt_pk_bf16_f32 v120, v156, v157
  v_cvt_pk_bf16_f32 v121, v158, v159
  v_cvt_pk_bf16_f32 v122, v160, v161
  v_cvt_pk_bf16_f32 v123, v162, v163
  buffer_store_dwordx4 v[120:123], v2, s[20:23], s29 offen nt
  s_add_u32 s29, s29, s33
  v_lshlrev_b32 v156, 16, v124
  v_and_b32 v157, s30, v124
  v_lshlrev_b32 v158, 16, v125
  v_and_b32 v159, s30, v125
  v_lshlrev_b32 v160, 16, v126
  v_and_b32 v161, s30, v126
  v_lshlrev_b32 v162, 16, v127
  v_and_b32 v163, s30, v127
  v_pk_fma_f32 v[156:157], v[156:157], v[154:155], v[154:155] op_sel:[0,0,1] op_sel_hi:[1,0,1]
  v_pk_fma_f32 v[158:159], v[158:159], v[154:155], v[154:155] op_sel:[0,0,1] op_sel_hi:[1,0,1]
  v_pk_fma_f32 v[160:161], v[160:161], v[154:155], v[154:155] op_sel:[0,0,1] op_sel_hi:[1,0,1]
  v_pk_fma_f32 v[162:163], v[162:163], v[154:155], v[154:155] op_sel:[0,0,1] op_sel_hi:[1,0,1]
  v_cvt_pk_bf16_f32 v124, v156, v157
  v_cvt_pk_bf16_f32 v125, v158, v159
  v_cvt_pk_bf16_f32 v126, v160, v161
  v_cvt_pk_bf16_f32 v127, v162, v163
  buffer_store_dwordx4 v[124:127], v3, s[20:23], s29 offen nt
  s_branch L_sdone
.p2align 12
L_store2:
  v_lshlrev_b32 v156, 16, v16
  v_and_b32 v157, s30, v16
  v_lshlrev_b32 v158, 16, v17
  v_and_b32 v159, s30, v17
  v_lshlrev_b32 v160, 16, v18
  v_and_b32 v161, s30, v18
  v_lshlrev_b32 v162, 16, v19
  v_and_b32 v163, s30, v19
  s_barrier
  ds_read_b128 v[128:131], v5 offset:4096
  ds_read_b128 v[132:135], v5 offset:4112
  ds_read_b128 v[136:139], v5 offset:4128
  ds_read_b128 v[140:143], v5 offset:4144
  ds_read_b128 v[144:147], v5 offset:4160
  ds_read_b128 v[148:151], v5 offset:4176
  ds_read_b128 v[152:155], v5 offset:4192
  s_waitcnt lgkmcnt(6)
  v_pk_fma_f32 v[156:157], v[156:157], v[128:129], v[128:129] op_sel:[0,0,1] op_sel_hi:[1,0,1]
  v_pk_fma_f32 v[158:159], v[158:159], v[128:129], v[128:129] op_sel:[0,0,1] op_sel_hi:[1,0,1]
  v_pk_fma_f32 v[160:161], v[160:161], v[128:129], v[128:129] op_sel:[0,0,1] op_sel_hi:[1,0,1]
  v_pk_fma_f32 v[162:163], v[162:163], v[128:129], v[128:129] op_sel:[0,0,1] op_sel_hi:[1,0,1]
  v_cvt_pk_bf16_f32 v16, v156, v157
  v_cvt_pk_bf16_f32 v17, v158, v159
  v_cvt_pk_bf16_f32 v18, v160, v161
  v_cvt_pk_bf16_f32 v19, v162, v163
  buffer_store_dwordx4 v[16:19], v2, s[20:23], s29 offen nt
  s_add_u32 s29, s29, s33
  v_lshlrev_b32 v156, 16, v20
  v_and_b32 v157, s30, v20
  v_lshlrev_b32 v158, 16, v21
  v_and_b32 v159, s30, v21
  v_lshlrev_b32 v160, 16, v22
  v_and_b32 v161, s30, v22
  v_lshlrev_b32 v162, 16, v23
  v_and_b32 v163, s30, v23
  v_pk_fma_f32 v[156:157], v[156:157], v[130:131], v[130:131] op_sel:[0,0,1] op_sel_hi:[1,0,1]
  v_pk_fma_f32 v[158:159], v[158:159], v[130:131], v[130:131] op_sel:[0,0,1] op_sel_hi:[1,0,1]
  v_pk_fma_f32 v[160:161], v[160:161], v[130:131], v[130:131] op_sel:[0,0,1] op_sel_hi:[1,0,1]
  v_pk_fma_f32 v[162:163], v[162:163], v[130:131], v[130:131] op_sel:[0,0,1] op_sel_hi:[1,0,1]
  v_cvt_pk_bf16_f32 v20, v156, v157
  v_cvt_pk_bf16_f32 v21, v158, v159
  v_cvt_pk_bf16_f32 v22, v160, v161
  v_cvt_pk_bf16_f32 v23, v162, v163
  buffer_store_dwordx4 v[20:23], v3, s[20:23], s29 offen nt
  s_add_u32 s29, s29, s33
  v_lshlrev_b32 v156, 16, v24
  v_and_b32 v157, s30, v24
  v_lshlrev_b32 v158, 16, v25
  v_and_b32 v159, s30, v25
  v_lshlrev_b32 v160, 16, v26
  v_and_b32 v161, s30, v26
  v_lshlrev_b32 v162, 16, v27
  v_and_b32 v163, s30, v27
  s_waitcnt lgkmcnt(5)
  v_pk_fma_f32 v[156:157], v[156:157], v[132:133], v[132:133] op_sel:[0,0,1] op_sel_hi:[1,0,1]
  v_pk_fma_f32 v[158:159], v[158:159], v[132:133], v[132:133] op_sel:[0,0,1] op_sel_hi:[1,0,1]
  v_pk_fma_f32 v[160:161], v[160:161], v[132:133], v[132:133] op_sel:[0,0,1] op_sel_hi:[1,0,1]
  v_pk_fma_f32 v[162:163], v[162:163], v[132:133], v[132:133] op_sel:[0,0,1] op_sel_hi:[1,0,1]
  v_cvt_pk_bf16_f32 v24, v156, v157
  v_cvt_pk_bf16_f32 v25, v158, v159
  v_cvt_pk_bf16_f32 v26, v160, v161
  v_cvt_pk_bf16_f32 v27, v162, v163
  buffer_store_dwordx4 v[24:27], v2, s[20:23], s29 offen nt
  s_add_u32 s29, s29, s33
  v_lshlrev_b32 v156, 16, v28
  v_and_b32 v157, s30, v28
  v_lshlrev_b32 v158, 16, v29
  v_and_b32 v159, s30, v29
  v_lshlrev_b32 v160, 16, v30
  v_and_b32 v161, s30, v30
  v_lshlrev_b32 v162, 16, v31
  v_and_b32 v163, s30, v31
  v_pk_fma_f32 v[156:157], v[156:157], v[134:135], v[134:135] op_sel:[0,0,1] op_sel_hi:[1,0,1]
  v_pk_fma_f32 v[158:159], v[158:159], v[134:135], v[134:135] op_sel:[0,0,1] op_sel_hi:[1,0,1]
  v_pk_fma_f32 v[160:161], v[160:161], v[134:135], v[134:135] op_sel:[0,0,1] op_sel_hi:[1,0,1]
  v_pk_fma_f32 v[162:163], v[162:163], v[134:135], v[134:135] op_sel:[0,0,1] op_sel_hi:[1,0,1]
  v_cvt_pk_bf16_f32 v28, v156, v157
  v_cvt_pk_bf16_f32 v29, v158, v159
  v_cvt_pk_bf16_f32 v30, v160, v161
  v_cvt_pk_bf16_f32 v31, v162, v163
  buffer_store_dwordx4 v[28:31], v3, s[20:23], s29 offen nt
  s_add_u32 s29, s29, s33
  v_lshlrev_b32 v156, 16, v32
  v_and_b32 v157, s30, v32
  v_lshlrev_b32 v158, 16, v33
  v_and_b32 v159, s30, v33
  v_lshlrev_b32 v160, 16, v34
  v_and_b32 v161, s30, v34
  v_lshlrev_b32 v162, 16, v35
  v_and_b32 v163, s30, v35
  s_waitcnt lgkmcnt(4)
  v_pk_fma_f32 v[156:157], v[156:157], v[136:137], v[136:137] op_sel:[0,0,1] op_sel_hi:[1,0,1]
  v_pk_fma_f32 v[158:159], v[158:159], v[136:137], v[136:137] op_sel:[0,0,1] op_sel_hi:[1,0,1]
  v_pk_fma_f32 v[160:161], v[160:161], v[136:137], v[136:137] op_sel:[0,0,1] op_sel_hi:[1,0,1]
  v_pk_fma_f32 v[162:163], v[162:163], v[136:137], v[136:137] op_sel:[0,0,1] op_sel_hi:[1,0,1]
  v_cvt_pk_bf16_f32 v32, v156, v157
  v_cvt_pk_bf16_f32 v33, v158, v159
  v_cvt_pk_bf16_f32 v34, v160, v161
  v_cvt_pk_bf16_f32 v35, v162, v163
  buffer_store_dwordx4 v[32:35], v2, s[20:23], s29 offen nt
  s_add_u32 s29, s29, s33
  v_lshlrev_b32 v156, 16, v36
  v_and_b32 v157, s30, v36
  v_lshlrev_b32 v158, 16, v37
  v_and_b32 v159, s30, v37
  v_lshlrev_b32 v160, 16, v38
  v_and_b32 v161, s30, v38
  v_lshlrev_b32 v162, 16, v39
  v_and_b32 v163, s30, v39
  v_pk_fma_f32 v[156:157], v[156:157], v[138:139], v[138:139] op_sel:[0,0,1] op_sel_hi:[1,0,1]
  v_pk_fma_f32 v[158:159], v[158:159], v[138:139], v[138:139] op_sel:[0,0,1] op_sel_hi:[1,0,1]
  v_pk_fma_f32 v[160:161], v[160:161], v[138:139], v[138:139] op_sel:[0,0,1] op_sel_hi:[1,0,1]
  v_pk_fma_f32 v[162:163], v[162:163], v[138:139], v[138:139] op_sel:[0,0,1] op_sel_hi:[1,0,1]
  v_cvt_pk_bf16_f32 v36, v156, v157
  v_cvt_pk_bf16_f32 v37, v158, v159
  v_cvt_pk_bf16_f32 v38, v160, v161
  v_cvt_pk_bf16_f32 v39, v162, v163
  buffer_store_dwordx4 v[36:39], v3, s[20:23], s29 offen nt
  s_add_u32 s29, s29, s33
  v_lshlrev_b32 v156, 16, v40
  v_and_b32 v157, s30, v40
  v_lshlrev_b32 v158, 16, v41
  v_and_b32 v159, s30, v41
  v_lshlrev_b32 v160, 16, v42
  v_and_b32 v161, s30, v42
  v_lshlrev_b32 v162, 16, v43
  v_and_b32 v163, s30, v43
  s_waitcnt lgkmcnt(3)
  v_pk_fma_f32 v[156:157], v[156:157], v[140:141], v[140:141] op_sel:[0,0,1] op_sel_hi:[1,0,1]
  v_pk_fma_f32 v[158:159], v[158:159], v[140:141], v[140:141] op_sel:[0,0,1] op_sel_hi:[1,0,1]
  v_pk_fma_f32 v[160:161], v[160:161], v[140:141], v[140:141] op_sel:[0,0,1] op_sel_hi:[1,0,1]
  v_pk_fma_f32 v[162:163], v[162:163], v[140:141], v[140:141] op_sel:[0,0,1] op_sel_hi:[1,0,1]
  v_cvt_pk_bf16_f32 v40, v156, v157
  v_cvt_pk_bf16_f32 v41, v158, v159
  v_cvt_pk_bf16_f32 v42, v160, v161
  v_cvt_pk_bf16_f32 v43, v162, v163
  buffer_store_dwordx4 v[40:43], v2, s[20:23], s29 offen nt
  s_add_u32 s29, s29, s33
  v_lshlrev_b32 v156, 16, v44
  v_and_b32 v157, s30, v44
  v_lshlrev_b32 v158, 16, v45
  v_and_b32 v159, s30, v45
  v_lshlrev_b32 v160, 16, v46
  v_and_b32 v161, s30, v46
  v_lshlrev_b32 v162, 16, v47
  v_and_b32 v163, s30, v47
  v_pk_fma_f32 v[156:157], v[156:157], v[142:143], v[142:143] op_sel:[0,0,1] op_sel_hi:[1,0,1]
  v_pk_fma_f32 v[158:159], v[158:159], v[142:143], v[142:143] op_sel:[0,0,1] op_sel_hi:[1,0,1]
  v_pk_fma_f32 v[160:161], v[160:161], v[142:143], v[142:143] op_sel:[0,0,1] op_sel_hi:[1,0,1]
  v_pk_fma_f32 v[162:163], v[162:163], v[142:143], v[142:143] op_sel:[0,0,1] op_sel_hi:[1,0,1]
  v_cvt_pk_bf16_f32 v44, v156, v157
  v_cvt_pk_bf16_f32 v45, v158, v159
  v_cvt_pk_bf16_f32 v46, v160, v161
  v_cvt_pk_bf16_f32 v47, v162, v163
  buffer_store_dwordx4 v[44:47], v3, s[20:23], s29 offen nt
  s_add_u32 s29, s29, s33
  v_lshlrev_b32 v156, 16, v48
  v_and_b32 v157, s30, v48
  v_lshlrev_b32 v158, 16, v49
  v_and_b32 v159, s30, v49
  v_lshlrev_b32 v160, 16, v50
  v_and_b32 v161, s30, v50
  v_lshlrev_b32 v162, 16, v51
  v_and_b32 v163, s30, v51
  s_waitcnt lgkmcnt(2)
  v_pk_fma_f32 v[156:157], v[156:157], v[144:145], v[144:145] op_sel:[0,0,1] op_sel_hi:[1,0,1]
  v_pk_fma_f32 v[158:159], v[158:159], v[144:145], v[144:145] op_sel:[0,0,1] op_sel_hi:[1,0,1]
  v_pk_fma_f32 v[160:161], v[160:161], v[144:145], v[144:145] op_sel:[0,0,1] op_sel_hi:[1,0,1]
  v_pk_fma_f32 v[162:163], v[162:163], v[144:145], v[144:145] op_sel:[0,0,1] op_sel_hi:[1,0,1]
  v_cvt_pk_bf16_f32 v48, v156, v157
  v_cvt_pk_bf16_f32 v49, v158, v159
  v_cvt_pk_bf16_f32 v50, v160, v161
  v_cvt_pk_bf16_f32 v51, v162, v163
  buffer_store_dwordx4 v[48:51], v2, s[20:23], s29 offen nt
  s_add_u32 s29, s29, s33
  v_lshlrev_b32 v156, 16, v52
  v_and_b32 v157, s30, v52
  v_lshlrev_b32 v158, 16, v53
  v_and_b32 v159, s30, v53
  v_lshlrev_b32 v160, 16, v54
  v_and_b32 v161, s30, v54
  v_lshlrev_b32 v162, 16, v55
  v_and_b32 v163, s30, v55
  v_pk_fma_f32 v[156:157], v[156:157], v[146:147], v[146:147] op_sel:[0,0,1] op_sel_hi:[1,0,1]
  v_pk_fma_f32 v[158:159], v[158:159], v[146:147], v[146:147] op_sel:[0,0,1] op_sel_hi:[1,0,1]
  v_pk_fma_f32 v[160:161], v[160:161], v[146:147], v[146:147] op_sel:[0,0,1] op_sel_hi:[1,0,1]
  v_pk_fma_f32 v[162:163], v[162:163], v[146:147], v[146:147] op_sel:[0,0,1] op_sel_hi:[1,0,1]
  v_cvt_pk_bf16_f32 v52, v156, v157
  v_cvt_pk_bf16_f32 v53, v158, v159
  v_cvt_pk_bf16_f32 v54, v160, v161
  v_cvt_pk_bf16_f32 v55, v162, v163
  buffer_store_dwordx4 v[52:55], v3, s[20:23], s29 offen nt
  s_add_u32 s29, s29, s33
  v_lshlrev_b32 v156, 16, v56
  v_and_b32 v157, s30, v56
  v_lshlrev_b32 v158, 16, v57
  v_and_b32 v159, s30, v57
  v_lshlrev_b32 v160, 16, v58
  v_and_b32 v161, s30, v58
  v_lshlrev_b32 v162, 16, v59
  v_and_b32 v163, s30, v59
  s_waitcnt lgkmcnt(1)
  v_pk_fma_f32 v[156:157], v[156:157], v[148:149], v[148:149] op_sel:[0,0,1] op_sel_hi:[1,0,1]
  v_pk_fma_f32 v[158:159], v[158:159], v[148:149], v[148:149] op_sel:[0,0,1] op_sel_hi:[1,0,1]
  v_pk_fma_f32 v[160:161], v[160:161], v[148:149], v[148:149] op_sel:[0,0,1] op_sel_hi:[1,0,1]
  v_pk_fma_f32 v[162:163], v[162:163], v[148:149], v[148:149] op_sel:[0,0,1] op_sel_hi:[1,0,1]
  v_cvt_pk_bf16_f32 v56, v156, v157
  v_cvt_pk_bf16_f32 v57, v158, v159
  v_cvt_pk_bf16_f32 v58, v160, v161
  v_cvt_pk_bf16_f32 v59, v162, v163
  buffer_store_dwordx4 v[56:59], v2, s[20:23], s29 offen nt
  s_add_u32 s29, s29, s33
  v_lshlrev_b32 v156, 16, v60
  v_and_b32 v157, s30, v60
  v_lshlrev_b32 v158, 16, v61
  v_and_b32 v159, s30, v61
  v_lshlrev_b32 v160, 16, v62
  v_and_b32 v161, s30, v62
  v_lshlrev_b32 v162, 16, v63
  v_and_b32 v163, s30, v63
  v_pk_fma_f32 v[156:157], v[156:157], v[150:151], v[150:151] op_sel:[0,0,1] op_sel_hi:[1,0,1]
  v_pk_fma_f32 v[158:159], v[158:159], v[150:151], v[150:151] op_sel:[0,0,1] op_sel_hi:[1,0,1]
  v_pk_fma_f32 v[160:161], v[160:161], v[150:151], v[150:151] op_sel:[0,0,1] op_sel_hi:[1,0,1]
  v_pk_fma_f32 v[162:163], v[162:163], v[150:151], v[150:151] op_sel:[0,0,1] op_sel_hi:[1,0,1]
  v_cvt_pk_bf16_f32 v60, v156, v157
  v_cvt_pk_bf16_f32 v61, v158, v159
  v_cvt_pk_bf16_f32 v62, v160, v161
  v_cvt_pk_bf16_f32 v63, v162, v163
  buffer_store_dwordx4 v[60:63], v3, s[20:23], s29 offen nt
  s_add_u32 s29, s29, s33
  v_lshlrev_b32 v156, 16, v64
  v_and_b32 v157, s30, v64
  v_lshlrev_b32 v158, 16, v65
  v_and_b32 v159, s30, v65
  v_lshlrev_b32 v160, 16, v66
  v_and_b32 v161, s30, v66
  v_lshlrev_b32 v162, 16, v67
  v_and_b32 v163, s30, v67
  s_waitcnt lgkmcnt(0)
  v_pk_fma_f32 v[156:157], v[156:157], v[152:153], v[152:153] op_sel:[0,0,1] op_sel_hi:[1,0,1]
  v_pk_fma_f32 v[158:159], v[158:159], v[152:153], v[152:153] op_sel:[0,0,1] op_sel_hi:[1,0,1]
  v_pk_fma_f32 v[160:161], v[160:161], v[152:153], v[152:153] op_sel:[0,0,1] op_sel_hi:[1,0,1]
  v_pk_fma_f32 v[162:163], v[162:163], v[152:153], v[152:153] op_sel:[0,0,1] op_sel_hi:[1,0,1]
  v_cvt_pk_bf16_f32 v64, v156, v157
  v_cvt_pk_bf16_f32 v65, v158, v159
  v_cvt_pk_bf16_f32 v66, v160, v161
  v_cvt_pk_bf16_f32 v67, v162, v163
  buffer_store_dwordx4 v[64:67], v2, s[20:23], s29 offen nt
  s_add_u32 s29, s29, s33
  v_lshlrev_b32 v156, 16, v68
  v_and_b32 v157, s30, v68
  v_lshlrev_b32 v158, 16, v69
  v_and_b32 v159, s30, v69
  v_lshlrev_b32 v160, 16, v70
  v_and_b32 v161, s30, v70
  v_lshlrev_b32 v162, 16, v71
  v_and_b32 v163, s30, v71
  v_pk_fma_f32 v[156:157], v[156:157], v[154:155], v[154:155] op_sel:[0,0,1] op_sel_hi:[1,0,1]
  v_pk_fma_f32 v[158:159], v[158:159], v[154:155], v[154:155] op_sel:[0,0,1] op_sel_hi:[1,0,1]
  v_pk_fma_f32 v[160:161], v[160:161], v[154:155], v[154:155] op_sel:[0,0,1] op_sel_hi:[1,0,1]
  v_pk_fma_f32 v[162:163], v[162:163], v[154:155], v[154:155] op_sel:[0,0,1] op_sel_hi:[1,0,1]
  v_cvt_pk_bf16_f32 v68, v156, v157
  v_cvt_pk_bf16_f32 v69, v158, v159
  v_cvt_pk_bf16_f32 v70, v160, v161
  v_cvt_pk_bf16_f32 v71, v162, v163
  buffer_store_dwordx4 v[68:71], v3, s[20:23], s29 offen nt
  s_add_u32 s29, s29, 13828096
  v_lshlrev_b32 v156, 16, v72
  v_and_b32 v157, s30, v72
  v_lshlrev_b32 v158, 16, v73
  v_and_b32 v159, s30, v73
  v_lshlrev_b32 v160, 16, v74
  v_and_b32 v161, s30, v74
  v_lshlrev_b32 v162, 16, v75
  v_and_b32 v163, s30, v75
  s_barrier
  ds_read_b128 v[128:131], v5 offset:4224
  ds_read_b128 v[132:135], v5 offset:4240
  ds_read_b128 v[136:139], v5 offset:4256
  ds_read_b128 v[140:143], v5 offset:4272
  ds_read_b128 v[144:147], v5 offset:4288
  ds_read_b128 v[148:151], v5 offset:4304
  ds_read_b128 v[152:155], v5 offset:4320
  s_waitcnt lgkmcnt(6)
  v_pk_fma_f32 v[156:157], v[156:157], v[128:129], v[128:129] op_sel:[0,0,1] op_sel_hi:[1,0,1]
  v_pk_fma_f32 v[158:159], v[158:159], v[128:129], v[128:129] op_sel:[0,0,1] op_sel_hi:[1,0,1]
  v_pk_fma_f32 v[160:161], v[160:161], v[128:129], v[128:129] op_sel:[0,0,1] op_sel_hi:[1,0,1]
  v_pk_fma_f32 v[162:163], v[162:163], v[128:129], v[128:129] op_sel:[0,0,1] op_sel_hi:[1,0,1]
  v_cvt_pk_bf16_f32 v72, v156, v157
  v_cvt_pk_bf16_f32 v73, v158, v159
  v_cvt_pk_bf16_f32 v74, v160, v161
  v_cvt_pk_bf16_f32 v75, v162, v163
  buffer_store_dwordx4 v[72:75], v2, s[20:23], s29 offen nt
  s_add_u32 s29, s29, s33
  v_lshlrev_b32 v156, 16, v76
  v_and_b32 v157, s30, v76
  v_lshlrev_b32 v158, 16, v77
  v_and_b32 v159, s30, v77
  v_lshlrev_b32 v160, 16, v78
  v_and_b32 v161, s30, v78
  v_lshlrev_b32 v162, 16, v79
  v_and_b32 v163, s30, v79
  v_pk_fma_f32 v[156:157], v[156:157], v[130:131], v[130:131] op_sel:[0,0,1] op_sel_hi:[1,0,1]
  v_pk_fma_f32 v[158:159], v[158:159], v[130:131], v[130:131] op_sel:[0,0,1] op_sel_hi:[1,0,1]
  v_pk_fma_f32 v[160:161], v[160:161], v[130:131], v[130:131] op_sel:[0,0,1] op_sel_hi:[1,0,1]
  v_pk_fma_f32 v[162:163], v[162:163], v[130:131], v[130:131] op_sel:[0,0,1] op_sel_hi:[1,0,1]
  v_cvt_pk_bf16_f32 v76, v156, v157
  v_cvt_pk_bf16_f32 v77, v158, v159
  v_cvt_pk_bf16_f32 v78, v160, v161
  v_cvt_pk_bf16_f32 v79, v162, v163
  buffer_store_dwordx4 v[76:79], v3, s[20:23], s29 offen nt
  s_add_u32 s29, s29, s33
  v_lshlrev_b32 v156, 16, v80
  v_and_b32 v157, s30, v80
  v_lshlrev_b32 v158, 16, v81
  v_and_b32 v159, s30, v81
  v_lshlrev_b32 v160, 16, v82
  v_and_b32 v161, s30, v82
  v_lshlrev_b32 v162, 16, v83
  v_and_b32 v163, s30, v83
  s_waitcnt lgkmcnt(5)
  v_pk_fma_f32 v[156:157], v[156:157], v[132:133], v[132:133] op_sel:[0,0,1] op_sel_hi:[1,0,1]
  v_pk_fma_f32 v[158:159], v[158:159], v[132:133], v[132:133] op_sel:[0,0,1] op_sel_hi:[1,0,1]
  v_pk_fma_f32 v[160:161], v[160:161], v[132:133], v[132:133] op_sel:[0,0,1] op_sel_hi:[1,0,1]
  v_pk_fma_f32 v[162:163], v[162:163], v[132:133], v[132:133] op_sel:[0,0,1] op_sel_hi:[1,0,1]
  v_cvt_pk_bf16_f32 v80, v156, v157
  v_cvt_pk_bf16_f32 v81, v158, v159
  v_cvt_pk_bf16_f32 v82, v160, v161
  v_cvt_pk_bf16_f32 v83, v162, v163
  buffer_store_dwordx4 v[80:83], v2, s[20:23], s29 offen nt
  s_add_u32 s29, s29, s33
  v_lshlrev_b32 v156, 16, v84
  v_and_b32 v157, s30, v84
  v_lshlrev_b32 v158, 16, v85
  v_and_b32 v159, s30, v85
  v_lshlrev_b32 v160, 16, v86
  v_and_b32 v161, s30, v86
  v_lshlrev_b32 v162, 16, v87
  v_and_b32 v163, s30, v87
  v_pk_fma_f32 v[156:157], v[156:157], v[134:135], v[134:135] op_sel:[0,0,1] op_sel_hi:[1,0,1]
  v_pk_fma_f32 v[158:159], v[158:159], v[134:135], v[134:135] op_sel:[0,0,1] op_sel_hi:[1,0,1]
  v_pk_fma_f32 v[160:161], v[160:161], v[134:135], v[134:135] op_sel:[0,0,1] op_sel_hi:[1,0,1]
  v_pk_fma_f32 v[162:163], v[162:163], v[134:135], v[134:135] op_sel:[0,0,1] op_sel_hi:[1,0,1]
  v_cvt_pk_bf16_f32 v84, v156, v157
  v_cvt_pk_bf16_f32 v85, v158, v159
  v_cvt_pk_bf16_f32 v86, v160, v161
  v_cvt_pk_bf16_f32 v87, v162, v163
  buffer_store_dwordx4 v[84:87], v3, s[20:23], s29 offen nt
  s_add_u32 s29, s29, s33
  v_lshlrev_b32 v156, 16, v88
  v_and_b32 v157, s30, v88
  v_lshlrev_b32 v158, 16, v89
  v_and_b32 v159, s30, v89
  v_lshlrev_b32 v160, 16, v90
  v_and_b32 v161, s30, v90
  v_lshlrev_b32 v162, 16, v91
  v_and_b32 v163, s30, v91
  s_waitcnt lgkmcnt(4)
  v_pk_fma_f32 v[156:157], v[156:157], v[136:137], v[136:137] op_sel:[0,0,1] op_sel_hi:[1,0,1]
  v_pk_fma_f32 v[158:159], v[158:159], v[136:137], v[136:137] op_sel:[0,0,1] op_sel_hi:[1,0,1]
  v_pk_fma_f32 v[160:161], v[160:161], v[136:137], v[136:137] op_sel:[0,0,1] op_sel_hi:[1,0,1]
  v_pk_fma_f32 v[162:163], v[162:163], v[136:137], v[136:137] op_sel:[0,0,1] op_sel_hi:[1,0,1]
  v_cvt_pk_bf16_f32 v88, v156, v157
  v_cvt_pk_bf16_f32 v89, v158, v159
  v_cvt_pk_bf16_f32 v90, v160, v161
  v_cvt_pk_bf16_f32 v91, v162, v163
  buffer_store_dwordx4 v[88:91], v2, s[20:23], s29 offen nt
  s_add_u32 s29, s29, s33
  v_lshlrev_b32 v156, 16, v92
  v_and_b32 v157, s30, v92
  v_lshlrev_b32 v158, 16, v93
  v_and_b32 v159, s30, v93
  v_lshlrev_b32 v160, 16, v94
  v_and_b32 v161, s30, v94
  v_lshlrev_b32 v162, 16, v95
  v_and_b32 v163, s30, v95
  v_pk_fma_f32 v[156:157], v[156:157], v[138:139], v[138:139] op_sel:[0,0,1] op_sel_hi:[1,0,1]
  v_pk_fma_f32 v[158:159], v[158:159], v[138:139], v[138:139] op_sel:[0,0,1] op_sel_hi:[1,0,1]
  v_pk_fma_f32 v[160:161], v[160:161], v[138:139], v[138:139] op_sel:[0,0,1] op_sel_hi:[1,0,1]
  v_pk_fma_f32 v[162:163], v[162:163], v[138:139], v[138:139] op_sel:[0,0,1] op_sel_hi:[1,0,1]
  v_cvt_pk_bf16_f32 v92, v156, v157
  v_cvt_pk_bf16_f32 v93, v158, v159
  v_cvt_pk_bf16_f32 v94, v160, v161
  v_cvt_pk_bf16_f32 v95, v162, v163
  buffer_store_dwordx4 v[92:95], v3, s[20:23], s29 offen nt
  s_add_u32 s29, s29, s33
  v_lshlrev_b32 v156, 16, v96
  v_and_b32 v157, s30, v96
  v_lshlrev_b32 v158, 16, v97
  v_and_b32 v159, s30, v97
  v_lshlrev_b32 v160, 16, v98
  v_and_b32 v161, s30, v98
  v_lshlrev_b32 v162, 16, v99
  v_and_b32 v163, s30, v99
  s_waitcnt lgkmcnt(3)
  v_pk_fma_f32 v[156:157], v[156:157], v[140:141], v[140:141] op_sel:[0,0,1] op_sel_hi:[1,0,1]
  v_pk_fma_f32 v[158:159], v[158:159], v[140:141], v[140:141] op_sel:[0,0,1] op_sel_hi:[1,0,1]
  v_pk_fma_f32 v[160:161], v[160:161], v[140:141], v[140:141] op_sel:[0,0,1] op_sel_hi:[1,0,1]
  v_pk_fma_f32 v[162:163], v[162:163], v[140:141], v[140:141] op_sel:[0,0,1] op_sel_hi:[1,0,1]
  v_cvt_pk_bf16_f32 v96, v156, v157
  v_cvt_pk_bf16_f32 v97, v158, v159
  v_cvt_pk_bf16_f32 v98, v160, v161
  v_cvt_pk_bf16_f32 v99, v162, v163
  buffer_store_dwordx4 v[96:99], v2, s[20:23], s29 offen nt
  s_add_u32 s29, s29, s33
  v_lshlrev_b32 v156, 16, v100
  v_and_b32 v157, s30, v100
  v_lshlrev_b32 v158, 16, v101
  v_and_b32 v159, s30, v101
  v_lshlrev_b32 v160, 16, v102
  v_and_b32 v161, s30, v102
  v_lshlrev_b32 v162, 16, v103
  v_and_b32 v163, s30, v103
  v_pk_fma_f32 v[156:157], v[156:157], v[142:143], v[142:143] op_sel:[0,0,1] op_sel_hi:[1,0,1]
  v_pk_fma_f32 v[158:159], v[158:159], v[142:143], v[142:143] op_sel:[0,0,1] op_sel_hi:[1,0,1]
  v_pk_fma_f32 v[160:161], v[160:161], v[142:143], v[142:143] op_sel:[0,0,1] op_sel_hi:[1,0,1]
  v_pk_fma_f32 v[162:163], v[162:163], v[142:143], v[142:143] op_sel:[0,0,1] op_sel_hi:[1,0,1]
  v_cvt_pk_bf16_f32 v100, v156, v157
  v_cvt_pk_bf16_f32 v101, v158, v159
  v_cvt_pk_bf16_f32 v102, v160, v161
  v_cvt_pk_bf16_f32 v103, v162, v163
  buffer_store_dwordx4 v[100:103], v3, s[20:23], s29 offen nt
  s_add_u32 s29, s29, s33
  v_lshlrev_b32 v156, 16, v104
  v_and_b32 v157, s30, v104
  v_lshlrev_b32 v158, 16, v105
  v_and_b32 v159, s30, v105
  v_lshlrev_b32 v160, 16, v106
  v_and_b32 v161, s30, v106
  v_lshlrev_b32 v162, 16, v107
  v_and_b32 v163, s30, v107
  s_waitcnt lgkmcnt(2)
  v_pk_fma_f32 v[156:157], v[156:157], v[144:145], v[144:145] op_sel:[0,0,1] op_sel_hi:[1,0,1]
  v_pk_fma_f32 v[158:159], v[158:159], v[144:145], v[144:145] op_sel:[0,0,1] op_sel_hi:[1,0,1]
  v_pk_fma_f32 v[160:161], v[160:161], v[144:145], v[144:145] op_sel:[0,0,1] op_sel_hi:[1,0,1]
  v_pk_fma_f32 v[162:163], v[162:163], v[144:145], v[144:145] op_sel:[0,0,1] op_sel_hi:[1,0,1]
  v_cvt_pk_bf16_f32 v104, v156, v157
  v_cvt_pk_bf16_f32 v105, v158, v159
  v_cvt_pk_bf16_f32 v106, v160, v161
  v_cvt_pk_bf16_f32 v107, v162, v163
  buffer_store_dwordx4 v[104:107], v2, s[20:23], s29 offen nt
  s_add_u32 s29, s29, s33
  v_lshlrev_b32 v156, 16, v108
  v_and_b32 v157, s30, v108
  v_lshlrev_b32 v158, 16, v109
  v_and_b32 v159, s30, v109
  v_lshlrev_b32 v160, 16, v110
  v_and_b32 v161, s30, v110
  v_lshlrev_b32 v162, 16, v111
  v_and_b32 v163, s30, v111
  v_pk_fma_f32 v[156:157], v[156:157], v[146:147], v[146:147] op_sel:[0,0,1] op_sel_hi:[1,0,1]
  v_pk_fma_f32 v[158:159], v[158:159], v[146:147], v[146:147] op_sel:[0,0,1] op_sel_hi:[1,0,1]
  v_pk_fma_f32 v[160:161], v[160:161], v[146:147], v[146:147] op_sel:[0,0,1] op_sel_hi:[1,0,1]
  v_pk_fma_f32 v[162:163], v[162:163], v[146:147], v[146:147] op_sel:[0,0,1] op_sel_hi:[1,0,1]
  v_cvt_pk_bf16_f32 v108, v156, v157
  v_cvt_pk_bf16_f32 v109, v158, v159
  v_cvt_pk_bf16_f32 v110, v160, v161
  v_cvt_pk_bf16_f32 v111, v162, v163
  buffer_store_dwordx4 v[108:111], v3, s[20:23], s29 offen nt
  s_add_u32 s29, s29, s33
  v_lshlrev_b32 v156, 16, v112
  v_and_b32 v157, s30, v112
  v_lshlrev_b32 v158, 16, v113
  v_and_b32 v159, s30, v113
  v_lshlrev_b32 v160, 16, v114
  v_and_b32 v161, s30, v114
  v_lshlrev_b32 v162, 16, v115
  v_and_b32 v163, s30, v115
  s_waitcnt lgkmcnt(1)
  v_pk_fma_f32 v[156:157], v[156:157], v[148:149], v[148:149] op_sel:[0,0,1] op_sel_hi:[1,0,1]
  v_pk_fma_f32 v[158:159], v[158:159], v[148:149], v[148:149] op_sel:[0,0,1] op_sel_hi:[1,0,1]
  v_pk_fma_f32 v[160:161], v[160:161], v[148:149], v[148:149] op_sel:[0,0,1] op_sel_hi:[1,0,1]
  v_pk_fma_f32 v[162:163], v[162:163], v[148:149], v[148:149] op_sel:[0,0,1] op_sel_hi:[1,0,1]
  v_cvt_pk_bf16_f32 v112, v156, v157
  v_cvt_pk_bf16_f32 v113, v158, v159
  v_cvt_pk_bf16_f32 v114, v160, v161
  v_cvt_pk_bf16_f32 v115, v162, v163
  buffer_store_dwordx4 v[112:115], v2, s[20:23], s29 offen nt
  s_add_u32 s29, s29, s33
  v_lshlrev_b32 v156, 16, v116
  v_and_b32 v157, s30, v116
  v_lshlrev_b32 v158, 16, v117
  v_and_b32 v159, s30, v117
  v_lshlrev_b32 v160, 16, v118
  v_and_b32 v161, s30, v118
  v_lshlrev_b32 v162, 16, v119
  v_and_b32 v163, s30, v119
  v_pk_fma_f32 v[156:157], v[156:157], v[150:151], v[150:151] op_sel:[0,0,1] op_sel_hi:[1,0,1]
  v_pk_fma_f32 v[158:159], v[158:159], v[150:151], v[150:151] op_sel:[0,0,1] op_sel_hi:[1,0,1]
  v_pk_fma_f32 v[160:161], v[160:161], v[150:151], v[150:151] op_sel:[0,0,1] op_sel_hi:[1,0,1]
  v_pk_fma_f32 v[162:163], v[162:163], v[150:151], v[150:151] op_sel:[0,0,1] op_sel_hi:[1,0,1]
  v_cvt_pk_bf16_f32 v116, v156, v157
  v_cvt_pk_bf16_f32 v117, v158, v159
  v_cvt_pk_bf16_f32 v118, v160, v161
  v_cvt_pk_bf16_f32 v119, v162, v163
  buffer_store_dwordx4 v[116:119], v3, s[20:23], s29 offen nt
  s_add_u32 s29, s29, s33
  v_lshlrev_b32 v156, 16, v120
  v_and_b32 v157, s30, v120
  v_lshlrev_b32 v158, 16, v121
  v_and_b32 v159, s30, v121
  v_lshlrev_b32 v160, 16, v122
  v_and_b32 v161, s30, v122
  v_lshlrev_b32 v162, 16, v123
  v_and_b32 v163, s30, v123
  s_waitcnt lgkmcnt(0)
  v_pk_fma_f32 v[156:157], v[156:157], v[152:153], v[152:153] op_sel:[0,0,1] op_sel_hi:[1,0,1]
  v_pk_fma_f32 v[158:159], v[158:159], v[152:153], v[152:153] op_sel:[0,0,1] op_sel_hi:[1,0,1]
  v_pk_fma_f32 v[160:161], v[160:161], v[152:153], v[152:153] op_sel:[0,0,1] op_sel_hi:[1,0,1]
  v_pk_fma_f32 v[162:163], v[162:163], v[152:153], v[152:153] op_sel:[0,0,1] op_sel_hi:[1,0,1]
  v_cvt_pk_bf16_f32 v120, v156, v157
  v_cvt_pk_bf16_f32 v121, v158, v159
  v_cvt_pk_bf16_f32 v122, v160, v161
  v_cvt_pk_bf16_f32 v123, v162, v163
  buffer_store_dwordx4 v[120:123], v2, s[20:23], s29 offen nt
  s_add_u32 s29, s29, s33
  v_lshlrev_b32 v156, 16, v124
  v_and_b32 v157, s30, v124
  v_lshlrev_b32 v158, 16, v125
  v_and_b32 v159, s30, v125
  v_lshlrev_b32 v160, 16, v126
  v_and_b32 v161, s30, v126
  v_lshlrev_b32 v162, 16, v127
  v_and_b32 v163, s30, v127
  v_pk_fma_f32 v[156:157], v[156:157], v[154:155], v[154:155] op_sel:[0,0,1] op_sel_hi:[1,0,1]
  v_pk_fma_f32 v[158:159], v[158:159], v[154:155], v[154:155] op_sel:[0,0,1] op_sel_hi:[1,0,1]
  v_pk_fma_f32 v[160:161], v[160:161], v[154:155], v[154:155] op_sel:[0,0,1] op_sel_hi:[1,0,1]
  v_pk_fma_f32 v[162:163], v[162:163], v[154:155], v[154:155] op_sel:[0,0,1] op_sel_hi:[1,0,1]
  v_cvt_pk_bf16_f32 v124, v156, v157
  v_cvt_pk_bf16_f32 v125, v158, v159
  v_cvt_pk_bf16_f32 v126, v160, v161
  v_cvt_pk_bf16_f32 v127, v162, v163
  buffer_store_dwordx4 v[124:127], v3, s[20:23], s29 offen nt
L_sdone:
  s_endpgm
L_tier2:
  s_mov_b32 exec_lo, 0
  s_mov_b32 exec_hi, s34
  buffer_store_dword v32, v4, s[12:15], s32 offen sc1
  s_mov_b64 exec, -1
  s_movk_i32 s24, 256
L_poll2:
  buffer_load_dword v35, v4, s[12:15], s32 offen sc1
  s_sub_u32 s24, s24, 1
  s_waitcnt vmcnt(0)
  v_xor_b32 v36, v35, v33
  v_and_b32 v36, 1, v36
  v_cmp_ne_u32 s[40:41], 0, v36
  v_mov_b32 v36, v35
  s_nop 1
  v_permlane32_swap_b32 v35, v36
  s_and_b32 s42, s40, s41
  s_mov_b32 s41, s40
  v_cndmask_b32 v35, v35, v36, s[40:41]
  s_cmp_eq_u32 s42, 0
  s_cbranch_scc1 L_got
  s_cmp_lg_u32 s24, 0
  s_cbranch_scc1 L_poll2
  s_mov_b32 s42, 0
L_fb_w:
  s_lshl_b32 s43, s42, 10
  v_add_u32 v2, s43, v8
  v_xor_b32 v3, 0x2000, v2
  s_mov_b32 s28, s36
  buffer_load_dwordx4 v[40:43], v2, s[16:19], s28 offen
  s_add_u32 s28, s28, 65536
  buffer_load_dwordx4 v[44:47], v3, s[16:19], s28 offen
  s_add_u32 s28, s28, 65536
  buffer_load_dwordx4 v[48:51], v2, s[16:19], s28 offen
  s_add_u32 s28, s28, 65536
  buffer_load_dwordx4 v[52:55], v3, s[16:19], s28 offen
  s_add_u32 s28, s28, 65536
  buffer_load_dwordx4 v[56:59], v2, s[16:19], s28 offen
  s_add_u32 s28, s28, 65536
  buffer_load_dwordx4 v[60:63], v3, s[16:19], s28 offen
  s_add_u32 s28, s28, 65536
  buffer_load_dwordx4 v[64:67], v2, s[16:19], s28 offen
  s_add_u32 s28, s28, 65536
  buffer_load_dwordx4 v[68:71], v3, s[16:19], s28 offen
  s_add_u32 s28, s28, 65536
  buffer_load_dwordx4 v[72:75], v2, s[16:19], s28 offen
  s_add_u32 s28, s28, 65536
  buffer_load_dwordx4 v[76:79], v3, s[16:19], s28 offen
  s_add_u32 s28, s28, 65536
  buffer_load_dwordx4 v[80:83], v2, s[16:19], s28 offen
  s_add_u32 s28, s28, 65536
  buffer_load_dwordx4 v[84:87], v3, s[16:19], s28 offen
  s_add_u32 s28, s28, 65536
  buffer_load_dwordx4 v[88:91], v2, s[16:19], s28 offen
  s_add_u32 s28, s28, 65536
  buffer_load_dwordx4 v[92:95], v3, s[16:19], s28 offen
  v_mov_b32 v10, 0
  v_mov_b32 v11, 0
  v_mov_b32 v12, 0
  v_mov_b32 v13, 0
  s_waitcnt vmcnt(0)
  v_dot2_f32_bf16 v10, v40, s31, v10
  v_dot2_f32_bf16 v11, v40, v40, v11
  v_dot2_f32_bf16 v12, v41, s31, v12
  v_dot2_f32_bf16 v13, v41, v41, v13
  v_dot2_f32_bf16 v10, v42, s31, v10
  v_dot2_f32_bf16 v11, v42, v42, v11
  v_dot2_f32_bf16 v12, v43, s31, v12
  v_dot2_f32_bf16 v13, v43, v43, v13
  v_dot2_f32_bf16 v10, v44, s31, v10
  v_dot2_f32_bf16 v11, v44, v44, v11
  v_dot2_f32_bf16 v12, v45, s31, v12
  v_dot2_f32_bf16 v13, v45, v45, v13
  v_dot2_f32_bf16 v10, v46, s31, v10
  v_dot2_f32_bf16 v11, v46, v46, v11
  v_dot2_f32_bf16 v12, v47, s31, v12
  v_dot2_f32_bf16 v13, v47, v47, v13
  v_dot2_f32_bf16 v10, v48, s31, v10
  v_dot2_f32_bf16 v11, v48, v48, v11
  v_dot2_f32_bf16 v12, v49, s31, v12
  v_dot2_f32_bf16 v13, v49, v49, v13
  v_dot2_f32_bf16 v10, v50, s31, v10
  v_dot2_f32_bf16 v11, v50, v50, v11
  v_dot2_f32_bf16 v12, v51, s31, v12
  v_dot2_f32_bf16 v13, v51, v51, v13
  v_dot2_f32_bf16 v10, v52, s31, v10
  v_dot2_f32_bf16 v11, v52, v52, v11
  v_dot2_f32_bf16 v12, v53, s31, v12
  v_dot2_f32_bf16 v13, v53, v53, v13
  v_dot2_f32_bf16 v10, v54, s31, v10
  v_dot2_f32_bf16 v11, v54, v54, v11
  v_dot2_f32_bf16 v12, v55, s31, v12
  v_dot2_f32_bf16 v13, v55, v55, v13
  v_dot2_f32_bf16 v10, v56, s31, v10
  v_dot2_f32_bf16 v11, v56, v56, v11
  v_dot2_f32_bf16 v12, v57, s31, v12
  v_dot2_f32_bf16 v13, v57, v57, v13
  v_dot2_f32_bf16 v10, v58, s31, v10
  v_dot2_f32_bf16 v11, v58, v58, v11
  v_dot2_f32_bf16 v12, v59, s31, v12
  v_dot2_f32_bf16 v13, v59, v59, v13
  v_dot2_f32_bf16 v10, v60, s31, v10
  v_dot2_f32_bf16 v11, v60, v60, v11
  v_dot2_f32_bf16 v12, v61, s31, v12
  v_dot2_f32_bf16 v13, v61, v61, v13
  v_dot2_f32_bf16 v10, v62, s31, v10
  v_dot2_f32_bf16 v11, v62, v62, v11
  v_dot2_f32_bf16 v12, v63, s31, v12
  v_dot2_f32_bf16 v13, v63, v63, v13
  v_dot2_f32_bf16 v10, v64, s31, v10
  v_dot2_f32_bf16 v11, v64, v64, v11
  v_dot2_f32_bf16 v12, v65, s31, v12
  v_dot2_f32_bf16 v13, v65, v65, v13
  v_dot2_f32_bf16 v10, v66, s31, v10
  v_dot2_f32_bf16 v11, v66, v66, v11
  v_dot2_f32_bf16 v12, v67, s31, v12
  v_dot2_f32_bf16 v13, v67, v67, v13
  v_dot2_f32_bf16 v10, v68, s31, v10
  v_dot2_f32_bf16 v11, v68, v68, v11
  v_dot2_f32_bf16 v12, v69, s31, v12
  v_dot2_f32_bf16 v13, v69, v69, v13
  v_dot2_f32_bf16 v10, v70, s31, v10
  v_dot2_f32_bf16 v11, v70, v70, v11
  v_dot2_f32_bf16 v12, v71, s31, v12
  v_dot2_f32_bf16 v13, v71, v71, v13
  v_dot2_f32_bf16 v10, v72, s31, v10
  v_dot2_f32_bf16 v11, v72, v72, v11
  v_dot2_f32_bf16 v12, v73, s31, v12
  v_dot2_f32_bf16 v13, v73, v73, v13
  v_dot2_f32_bf16 v10, v74, s31, v10
  v_dot2_f32_bf16 v11, v74, v74, v11
  v_dot2_f32_bf16 v12, v75, s31, v12
  v_dot2_f32_bf16 v13, v75, v75, v13
  v_dot2_f32_bf16 v10, v76, s31, v10
  v_dot2_f32_bf16 v11, v76, v76, v11
  v_dot2_f32_bf16 v12, v77, s31, v12
  v_dot2_f32_bf16 v13, v77, v77, v13
  v_dot2_f32_bf16 v10, v78, s31, v10
  v_dot2_f32_bf16 v11, v78, v78, v11
  v_dot2_f32_bf16 v12, v79, s31, v12
  v_dot2_f32_bf16 v13, v79, v79, v13
  v_dot2_f32_bf16 v10, v80, s31, v10
  v_dot2_f32_bf16 v11, v80, v80, v11
  v_dot2_f32_bf16 v12, v81, s31, v12
  v_dot2_f32_bf16 v13, v81, v81, v13
  v_dot2_f32_bf16 v10, v82, s31, v10
  v_dot2_f32_bf16 v11, v82, v82, v11
  v_dot2_f32_bf16 v12, v83, s31, v12
  v_dot2_f32_bf16 v13, v83, v83, v13
  v_dot2_f32_bf16 v10, v84, s31, v10
  v_dot2_f32_bf16 v11, v84, v84, v11
  v_dot2_f32_bf16 v12, v85, s31, v12
  v_dot2_f32_bf16 v13, v85, v85, v13
  v_dot2_f32_bf16 v10, v86, s31, v10
  v_dot2_f32_bf16 v11, v86, v86, v11
  v_dot2_f32_bf16 v12, v87, s31, v12
  v_dot2_f32_bf16 v13, v87, v87, v13
  v_dot2_f32_bf16 v10, v88, s31, v10
  v_dot2_f32_bf16 v11, v88, v88, v11
  v_dot2_f32_bf16 v12, v89, s31, v12
  v_dot2_f32_bf16 v13, v89, v89, v13
  v_dot2_f32_bf16 v10, v90, s31, v10
  v_dot2_f32_bf16 v11, v90, v90, v11
  v_dot2_f32_bf16 v12, v91, s31, v12
  v_dot2_f32_bf16 v13, v91, v91, v13
  v_dot2_f32_bf16 v10, v92, s31, v10
  v_dot2_f32_bf16 v11, v92, v92, v11
  v_dot2_f32_bf16 v12, v93, s31, v12
  v_dot2_f32_bf16 v13, v93, v93, v13
  v_dot2_f32_bf16 v10, v94, s31, v10
  v_dot2_f32_bf16 v11, v94, v94, v11
  v_dot2_f32_bf16 v12, v95, s31, v12
  v_dot2_f32_bf16 v13, v95, v95, v13
  s_nop 2
  v_pk_add_f32 v[10:11], v[10:11], v[12:13]
  s_bitcmp1_b32 s42, 0
  s_cbranch_scc1 L_fb_odd
  v_mov_b32 v26, v10
  v_mov_b32 v27, v11
  s_branch L_fb_cont
L_fb_odd:
  v_pk_add_f32 v[26:27], v[26:27], v[10:11]
  s_bitcmp1_b32 s42, 1
  s_cbranch_scc1 L_fb_last
  v_mov_b32 v24, v26
  v_mov_b32 v25, v27
  s_branch L_fb_cont
L_fb_last:
  v_pk_add_f32 v[24:25], v[24:25], v[26:27]
  v_cndmask_b32 v28, v24, v25, s[8:9]
  v_cndmask_b32 v29, v25, v24, s[8:9]
  s_nop 1
  v_add_f32_dpp v28, v29, v28 quad_perm:[1,0,3,2] row_mask:0xf bank_mask:0xf
  s_nop 1
  v_add_f32_dpp v28, v28, v28 quad_perm:[2,3,0,1] row_mask:0xf bank_mask:0xf
  s_nop 1
  v_add_f32_dpp v28, v28, v28 row_ror:4 row_mask:0xf bank_mask:0xf
  s_nop 1
  v_add_f32_dpp v28, v28, v28 row_ror:8 row_mask:0xf bank_mask:0xf
  v_mov_b32 v29, v28
  s_nop 1
  v_permlane16_swap_b32 v28, v29
  v_add_f32 v28, v28, v29
  v_mov_b32 v29, v28
  s_nop 1
  v_permlane32_swap_b32 v28, v29
  v_add_f32 v28, v28, v29
  s_lshr_b32 s43, s42, 1
  s_and_b32 s43, s43, 30
  s_lshl_b64 s[40:41], 3, s43
  v_cndmask_b32 v35, v35, v28, s[40:41]
L_fb_cont:
  s_add_u32 s42, s42, 1
  s_cmp_lg_u32 s42, 64
  s_cbranch_scc1 L_fb_w
  s_branch L_got
.section .rodata,"a"
.p2align 6
.amdhsa_kernel standalone__groupnorm__prompt_kernel
  .amdhsa_next_free_vgpr 164
  .amdhsa_next_free_sgpr 64
  .amdhsa_accum_offset 164
  .amdhsa_group_segment_fixed_size 0
  .amdhsa_kernarg_size 48
  .amdhsa_user_sgpr_count 2
  .amdhsa_user_sgpr_kernarg_segment_ptr 1
  .amdhsa_system_sgpr_workgroup_id_x 1
  .amdhsa_float_denorm_mode_32 3
.end_amdhsa_kernel
```
